```python
import torch

def _softmax(x, axis=-1):
    return torch.softmax(x, dim=axis)

def _gelu(x):
    return torch.nn.functional.gelu(x, approximate='tanh')

def _silu(x):
    return torch.nn.functional.silu(x)

def _sigmoid(x):
    return torch.sigmoid(x)

def _layernorm(x, axis=-1, eps=1e-05):
    m = x.mean(dim=axis, keepdim=True)
    v = x.var(dim=axis, keepdim=True, unbiased=False)
    return (x - m) / torch.sqrt(v + eps)

def _scatter_add(tgt, idx, src, axis=0):
    return tgt.clone().index_add_(axis, idx, src)

def _segment_sum(src, seg, n):
    out = torch.zeros((n,) + src.shape[1:], dtype=src.dtype)
    return out.index_add_(0, seg, src)

def _pad(x, pw):
    flat = tuple((v for pair in reversed(pw) for v in pair))
    return torch.nn.functional.pad(x, flat)
kernel_name = 'adaLN_cond__linear_kernel_hedgehog__geglu_ffn__prompt'

def setup_inputs():

    _w = lambda a: (lambda t: t.to(torch.bfloat16) if t.is_floating_point() else t)(torch.as_tensor(a))

    def _A_setup():
        B, S, D, H = (1, 2048, 512, 32)
        Dh = D // H
        return {'x': _w((lambda *s: torch.randn(*s, dtype=torch.bfloat16) * 0.1)(B, S, D)), 'wqkv': _w((lambda *s: torch.randn(*s, dtype=torch.bfloat16) * 0.2)(D, 3 * D)), 'w_phi': _w((lambda *s: torch.randn(*s, dtype=torch.bfloat16) * 0.2)(H, Dh, Dh) * Dh ** (-0.5)), 'wo': _w((lambda *s: torch.randn(*s, dtype=torch.bfloat16) * 0.2)(D, D))}
    _A_in = _A_setup()

    def _B_setup():
        B, S, D, F = (1, 2048, 512, 1376)
        return {'x': _w((lambda *s: torch.randn(*s, dtype=torch.bfloat16) * 0.1)(B, S, D)), 'w_gate': _w((lambda *s: torch.randn(*s, dtype=torch.bfloat16) * 0.8)(D, F)), 'w_up': _w((lambda *s: torch.randn(*s, dtype=torch.bfloat16) * 0.8)(D, F)), 'w_down': _w((lambda *s: torch.randn(*s, dtype=torch.bfloat16) * 0.8)(F, D))}
    _B_in = _B_setup()
    return {'A_x': _A_in['x'], 'A_wqkv': _A_in['wqkv'], 'A_w_phi': _A_in['w_phi'], 'A_wo': _A_in['wo'], 'B_x': _B_in['x'], 'B_w_gate': _B_in['w_gate'], 'B_w_up': _B_in['w_up'], 'B_w_down': _B_in['w_down'], 'c': _w((lambda *s: torch.randn(*s, dtype=torch.bfloat16) * 0.4)(1, 512) * 8.0), 'w_mod': _w((lambda *s: torch.randn(*s, dtype=torch.bfloat16) * 0.4)(512, 6 * 512) * 512 ** (-0.5) * 8.0)}

def reference(A_x, A_wqkv, A_w_phi, A_wo, B_x, B_w_gate, B_w_up, B_w_down, c, w_mod):

    def _A_ref(x, wqkv, w_phi, wo):
        B, S, D = x.shape
        H = 32
        Dh = D // H
        qkv = (lambda x, *d: x.permute(*d))((x @ wqkv).reshape(B, S, 3, H, Dh), 2, 0, 3, 1, 4)
        q, k, v = (qkv[0], qkv[1], qkv[2])
        pq = torch.einsum('bhsd,hdf->bhsf', q, w_phi)
        pk = torch.einsum('bhsd,hdf->bhsf', k, w_phi)
        phi_q = torch.concatenate([_softmax(pq, axis=-1), _softmax(-pq, axis=-1)], axis=-1)
        phi_k = torch.concatenate([_softmax(pk, axis=-1), _softmax(-pk, axis=-1)], axis=-1)
        kv = torch.einsum('bhsf,bhsd->bhfd', phi_k, v)
        z = torch.einsum('bhsf->bhf', phi_k)
        num = torch.einsum('bhqf,bhfd->bhqd', phi_q, kv)
        den = torch.einsum('bhqf,bhf->bhq', phi_q, z)[..., None] + 1e-06
        o = num / den
        return (lambda x, *d: x.permute(*d))(o, 0, 2, 1, 3).reshape(B, S, D) @ wo

    def _B_ref(x, w_gate, w_up, w_down):
        return _gelu(x @ w_gate) * (x @ w_up) @ w_down
    x = A_x
    mod = (_silu(c) @ w_mod).reshape(c.shape[0], 6, 1, -1)
    sa, ca, ga, sb, cb, gb = (mod[:, 0].clone(), mod[:, 1].clone(), mod[:, 2].clone(), mod[:, 3].clone(), mod[:, 4].clone(), mod[:, 5].clone())
    h = _layernorm(x, axis=-1) * (1 + ca) + sa
    x = x + ga * _A_ref(h, A_wqkv, A_w_phi, A_wo)
    h = _layernorm(x, axis=-1) * (1 + cb) + sb
    x = x + gb * _B_ref(h, B_w_gate, B_w_up, B_w_down)
    return x
```

```asm
; @launch grid=(256,1,1) block=(256,1,1) lds=163840
.amdgcn_target "amdgcn-amd-amdhsa--gfx950"
.text
.globl adaLN_cond__linear_kernel_hedgehog__geglu_ffn__prompt_kernel
.p2align 12
.fill 832, 4, 0xbf800000
.p2align 8
.type adaLN_cond__linear_kernel_hedgehog__geglu_ffn__prompt_kernel,@function
adaLN_cond__linear_kernel_hedgehog__geglu_ffn__prompt_kernel:
    s_cmp_ge_u32 s2, 256
    s_cbranch_scc1 L_end
    s_load_dwordx16 s[16:31], s[0:1], 40
    s_load_dwordx8 s[48:55], s[0:1], 0
    s_getpc_b64 s[4:5]
L_pc:
    s_lshr_b32 s3, s2, 3
    s_lshl_b32 s3, s3, 11
    v_lshl_add_u32 v4, v0, 7, s3
    v_min_u32 v4, L_last-L_pc, v4
    v_cmp_gt_u32 vcc, 16, v0
    s_and_saveexec_b64 s[6:7], vcc
    s_cbranch_execz L_nocpf
    global_load_dword v255, v4, s[4:5]
L_nocpf:
    s_mov_b64 exec, -1
    v_lshrrev_b32 v21, 6, v0
    v_and_b32 v1, 63, v0
    v_readfirstlane_b32 s62, v21
    s_and_b32 s60, s2, 7
    s_bfe_u32 s63, s2, 0x10004
    s_lshl1_add_u32 s60, s60, s63
    s_bfe_u32 s63, s2, 0x20003
    s_lshr_b32 s78, s2, 5
    s_and_b32 s64, s63, 1
    s_lshl3_add_u32 s61, s64, s78
    s_lshr_b32 s76, s62, 1
    s_and_b32 s63, s62, 1
    s_lshl1_add_u32 s77, s64, s63
    s_lshl4_add_u32 s71, s60, s61
    s_and_b32 s79, s2, 3
    s_bfe_u32 s64, s2, 0x10002
    s_bfe_u32 s80, s2, 0x40003
    s_lshl4_add_u32 s80, s64, s80
    s_lshr_b32 s63, s2, 7
    s_lshl1_add_u32 s64, s80, s63
    s_add_u32 s64, s64, 32
    s_or_b32 s63, s63, s62
    s_cselect_b32 s81, 0, 1
    s_cmp_eq_u32 s62, 2
    s_cselect_b32 s80, s64, s80
    s_cselect_b32 s81, 2, s81
    s_mov_b32 s42, 3145728
    s_mov_b32 s43, 0x20000
    s_mov_b32 s38, 1024
    s_mov_b32 s39, s43
    s_mov_b32 s10, 2097152
    s_mov_b32 s11, s43
    v_lshrrev_b32 v24, 2, v1
    v_and_b32 v25, 3, v1
    v_mul_u32_u24 v220, 49152, v24
    v_lshl_add_u32 v220, v25, 4, v220
    v_lshlrev_b32 v221, 2, v1
    v_and_b32 v21, 7, v1
    v_lshrrev_b32 v22, 3, v1
    v_lshlrev_b32 v104, 10, v21
    v_lshl_add_u32 v104, v22, 4, v104
    s_lshl_b32 s65, s71, 13
    s_lshl_b32 s64, s62, 8
    s_add_u32 s65, s65, s64
    v_lshlrev_b32 v254, 5, v25
    s_lshr_b32 s67, s2, 3
    s_lshl2_add_u32 s67, s67, s62
    s_lshl_b32 s64, s79, 7
    s_add_u32 s67, s67, s64
    s_mul_i32 s67, s67, 6
    s_bfe_u32 s64, s2, 0x10002
    s_add_u32 s67, s67, s64
    s_lshl_b32 s67, s67, 10
    s_waitcnt lgkmcnt(0)
    s_mov_b64 s[36:37], s[22:23]
    s_mov_b64 s[40:41], s[24:25]
    s_mov_b64 s[8:9], s[48:49]
    s_load_dword s83, s[30:31], 36864
    buffer_load_dword v255, v254, s[40:43], s67 offen offset:384
    s_cmp_lg_u32 s81, 1
    s_cbranch_scc1 L_skip_1
    s_lshl_b32 s66, s79, 8
    s_mul_i32 s63, s79, 786432
    s_lshl_b32 s64, s80, 6
    s_add_u32 s63, s63, s64
    buffer_load_dword v192, v221, s[36:39], s66 offen
    buffer_load_dwordx4 v[160:163], v220, s[40:43], s63 offen nt
    s_add_u32 s63, s63, 6144
    buffer_load_dwordx4 v[164:167], v220, s[40:43], s63 offen nt
    s_add_u32 s63, s63, 6144
    buffer_load_dwordx4 v[168:171], v220, s[40:43], s63 offen nt
    s_add_u32 s63, s63, 6144
    buffer_load_dwordx4 v[172:175], v220, s[40:43], s63 offen nt
    s_add_u32 s63, s63, 6144
    buffer_load_dwordx4 v[176:179], v220, s[40:43], s63 offen nt
    s_add_u32 s63, s63, 6144
    buffer_load_dwordx4 v[180:183], v220, s[40:43], s63 offen nt
    s_add_u32 s63, s63, 6144
    buffer_load_dwordx4 v[184:187], v220, s[40:43], s63 offen nt
    s_add_u32 s63, s63, 6144
    buffer_load_dwordx4 v[188:191], v220, s[40:43], s63 offen nt
L_skip_1:
    buffer_load_dwordx4 v[96:99], v104, s[8:11], s65 offen
    buffer_load_dwordx4 v[100:103], v104, s[8:11], s65 offen offset:128
    s_mov_b64 s[12:13], s[50:51]
    s_mov_b64 s[32:33], s[20:21]
    s_mov_b64 s[44:45], s[26:27]
    s_bitcmp1_b32 s62, 0
    s_cselect_b64 s[56:57], s[18:19], s[16:17]
    s_mov_b64 s[16:17], s[52:53]
    s_mov_b64 s[20:21], s[54:55]
    s_mov_b64 s[52:53], s[30:31]
    s_bfe_u32 s63, s2, 0x10003
    s_lshl2_add_u32 s82, s63, s2
    s_and_b32 s82, s82, 7
    s_bfe_u32 s63, s2, 0x10004
    s_lshl2_add_u32 s73, s63, s2
    s_bfe_u32 s63, s78, 0x20001
    s_lshl1_add_u32 s73, s63, s73
    s_and_b32 s73, s73, 7
    s_and_b32 s63, s2, 7
    s_mul_i32 s63, s63, 5
    s_lshr_b32 s74, s63, 2
    s_lshl_b32 s74, s74, 17
    s_mov_b32 s54, 33554432
    s_mov_b32 s55, s43
    s_mov_b32 s14, 1572864
    s_mov_b32 s15, s43
    s_mov_b32 s18, 16384
    s_mov_b32 s19, s43
    s_mov_b32 s22, 524288
    s_mov_b32 s23, s43
    s_mov_b32 s34, 1409024
    s_mov_b32 s35, s43
    s_mov_b32 s46, 2097152
    s_mov_b32 s47, s43
    s_mov_b32 s58, 1409024
    s_mov_b32 s59, s43
    v_lshlrev_b32 v2, 4, v1
    s_mul_i32 s63, s62, 49152
    s_lshl_b32 s64, s61, 6
    s_add_u32 s63, s63, s64
    v_mul_u32_u24 v3, 3072, v24
    v_lshl_add_u32 v25, v25, 4, s63
    v_add_u32 v3, v3, v25
    s_lshl_b32 s71, s71, 7
    s_mul_i32 s4, s62, 3072
    s_lshl_b32 s5, s62, 10
    s_lshl_b32 s73, s73, 12
    s_add_u32 s3, s73, 4096
    s_and_b32 s3, s3, 0x7fff
    s_add_u32 s6, s3, 4096
    s_and_b32 s6, s6, 0x7fff
    s_add_u32 s7, s6, 4096
    s_and_b32 s7, s7, 0x7fff
    s_add_u32 s26, s7, 4096
    s_and_b32 s26, s26, 0x7fff
    s_add_u32 s27, s26, 4096
    s_and_b32 s27, s27, 0x7fff
    s_add_u32 s30, s27, 4096
    s_and_b32 s30, s30, 0x7fff
    s_add_u32 s31, s30, 4096
    s_and_b32 s31, s31, 0x7fff
    s_lshl1_add_u32 m0, s5, 31744
    s_mul_i32 s84, s73, 48
    buffer_load_dwordx4 v3, s[12:15], s84 offen offset:1024 lds
    buffer_load_dwordx4 v3, s[12:15], s84 offen offset:2048 lds
    s_add_u32 m0, s5, 0
    s_nop 0
    buffer_load_dwordx4 v3, s[12:15], s84 offen lds
    s_mov_b32 m0, 135168
    s_lshl_b32 s63, s61, 10
    buffer_load_dwordx4 v2, s[16:19], s63 offen lds
    v_lshlrev_b32 v20, 9, v22
    v_lshl_add_u32 v20, v21, 4, v20
    v_and_b32 v23, 2, v22
    v_lshlrev_b32 v23, 1, v23
    v_xor_b32 v23, v23, v21
    s_lshl_b32 s63, s78, 7
    s_lshl3_add_u32 s63, s5, s63
    v_lshl_add_u32 v23, v23, 4, s63
    v_lshl_add_u32 v4, v22, 10, v23
    v_add_u32 v27, 32768, v4
    s_mov_b32 s68, 0x00003f80
    s_mov_b32 s69, 0x3f800000
    s_mov_b32 s70, 0x3fb8aa3b
    s_cmp_eq_u32 s61, 15
    s_cselect_b32 s63, s60, s61
    s_and_b32 s66, s63, 1
    s_mul_i32 s63, s63, 192
    s_mul_i32 s64, s76, 44032
    s_add_u32 s63, s63, s64
    s_bitcmp1_b32 s62, 0
    s_cselect_b32 s64, 2, 0
    v_bfe_u32 v84, v1, 4, 1
    v_bfe_u32 v85, v1, 2, 2
    v_and_b32 v86, 3, v1
    v_lshrrev_b32 v87, 5, v1
    v_lshl_add_u32 v88, v87, 3, v85
    v_lshlrev_b32 v8, 6, v88
    v_lshlrev_b32 v89, 5, v84
    v_lshl_add_u32 v89, v86, 3, v89
    v_add_u32 v8, v8, v89
    v_add_u32 v9, 32768, v8
    v_lshl_add_u32 v88, v87, 2, v85
    v_lshl_add_u32 v10, v88, 7, v89
    v_and_b32 v90, 2, v85
    v_lshl_add_u32 v10, v90, 5, v10
    v_xor_b32 v11, 64, v10
    v_xor_b32 v12, s66, v88
    v_mul_u32_u24 v12, 192, v12
    v_lshl_add_u32 v12, v84, 4, v12
    v_and_b32 v90, 1, v86
    v_lshl_add_u32 v12, v90, 3, v12
    v_lshrrev_b32 v90, 1, v86
    v_mul_u32_u24 v91, 3040, v90
    v_add_u32 v13, v12, v91
    v_lshl_add_u32 v12, v90, 6, v13
    v_add_u32 v14, 61440, v12
    v_add_u32 v15, 61440, v13
    v_add_u32 v16, 122880, v12
    v_add_u32 v17, 122880, v13
    v_lshlrev_b32 v92, 5, v88
    v_lshl_add_u32 v92, v84, 4, v92
    v_lshl_add_u32 v92, v90, 3, v92
    v_add_u32 v92, 135168, v92
    v_add_u32 v90, 0, v1
    v_mul_u32_u24 v91, 0x5556, v90
    v_lshrrev_b32 v91, 18, v91
    v_mul_u32_u24 v89, 12, v91
    v_sub_u32 v90, v90, v89
    v_xor_b32 v90, s64, v90
    v_xor_b32 v91, s66, v91
    v_mul_u32_u24 v91, 2752, v91
    v_lshl_add_u32 v90, v90, 4, s63
    v_add_u32 v5, v90, v91
    s_sub_u32 s63, s63, 1024
    v_add_u32 v90, 64, v1
    v_mul_u32_u24 v91, 0x5556, v90
    v_lshrrev_b32 v91, 18, v91
    v_mul_u32_u24 v89, 12, v91
    v_sub_u32 v90, v90, v89
    v_xor_b32 v90, s64, v90
    v_xor_b32 v91, s66, v91
    v_mul_u32_u24 v91, 2752, v91
    v_lshl_add_u32 v90, v90, 4, s63
    v_add_u32 v6, v90, v91
    s_sub_u32 s63, s63, 1024
    v_add_u32 v90, 128, v1
    v_mul_u32_u24 v91, 0x5556, v90
    v_lshrrev_b32 v91, 18, v91
    v_mul_u32_u24 v89, 12, v91
    v_sub_u32 v90, v90, v89
    v_xor_b32 v90, s64, v90
    v_xor_b32 v91, s66, v91
    v_mul_u32_u24 v91, 2752, v91
    v_lshl_add_u32 v90, v90, 4, s63
    v_add_u32 v7, v90, v91
    s_lshl_b32 s63, s60, 11
    v_lshl_add_u32 v18, v1, 7, s63
    s_lshl_b32 s63, s61, 7
    s_add_u32 s63, s63, 0x20000
    v_lshl_add_u32 v19, v1, 11, s63
    v_cvt_f32_u32 v94, v87
    s_lshl_b32 s63, s62, 9
    s_add_u32 s63, s63, 65536
    v_and_b32 v93, 31, v1
    v_lshl_add_u32 v93, v93, 4, s63
    v_lshl_add_u32 v93, v87, 11, v93
    s_lshl_b32 s63, s60, 20
    s_add_u32 s63, s63, 2097152
    s_add_u32 s16, s52, s63
    s_addc_u32 s17, s53, 0
    s_mov_b32 s18, 0x100000
    s_waitcnt lgkmcnt(0)
    s_mul_i32 s72, s83, 0x9E3779B1
    s_add_u32 s72, s72, 0x5BD1E993
    s_bfe_u32 s48, s72, 0x80000
    s_bfe_u32 s49, s72, 0x80008
    s_bfe_u32 s50, s72, 0x80010
    s_bfe_u32 s51, s72, 0x80018
    s_getreg_b32 s28, hwreg(HW_REG_XCC_ID, 0, 4)
    s_add_u32 s28, s28, s72
    s_add_u32 s28, s28, 8
    s_cmp_lg_u32 s62, 1
    s_cbranch_scc1 L_pub_2
    v_mov_b32 v252, s28
    s_mov_b64 exec, 1
    buffer_store_dword v252, off, s[52:55], s71 offset:4 sc1
    s_mov_b64 exec, -1
    s_waitcnt vmcnt(5)
    s_branch L_xok_3
L_pub_2:
    s_cmp_lg_u32 s81, 2
    s_cbranch_scc1 L_skip_4
    s_lshl_b32 s66, s79, 8
    s_mul_i32 s63, s79, 786432
    s_lshl_b32 s64, s80, 6
    s_add_u32 s63, s63, s64
    buffer_load_dword v192, v221, s[36:39], s66 offen
    buffer_load_dwordx4 v[160:163], v220, s[40:43], s63 offen nt
    s_add_u32 s63, s63, 6144
    buffer_load_dwordx4 v[164:167], v220, s[40:43], s63 offen nt
    s_add_u32 s63, s63, 6144
    buffer_load_dwordx4 v[168:171], v220, s[40:43], s63 offen nt
    s_add_u32 s63, s63, 6144
    buffer_load_dwordx4 v[172:175], v220, s[40:43], s63 offen nt
    s_add_u32 s63, s63, 6144
    buffer_load_dwordx4 v[176:179], v220, s[40:43], s63 offen nt
    s_add_u32 s63, s63, 6144
    buffer_load_dwordx4 v[180:183], v220, s[40:43], s63 offen nt
    s_add_u32 s63, s63, 6144
    buffer_load_dwordx4 v[184:187], v220, s[40:43], s63 offen nt
    s_add_u32 s63, s63, 6144
    buffer_load_dwordx4 v[188:191], v220, s[40:43], s63 offen nt
    s_waitcnt vmcnt(13)
    s_branch L_xok_3
L_skip_4:
    s_cmp_lg_u32 s81, 1
    s_cbranch_scc1 L_skip_5
    s_mov_b64 vcc, 0xffff
    v_lshlrev_b32 v208, 4, v1
    v_and_b32 v210, 16, v1
    v_lshlrev_b64 v[204:205], v208, vcc
    v_lshrrev_b32 v210, v210, s72
    v_mov_b32 v193, 0xff
    v_lshrrev_b32 v211, 8, v210
    v_and_b32 v194, 3, v1
    v_lshlrev_b32 v194, 5, v194
    v_lshrrev_b32 v195, 4, v1
    v_lshl_add_u32 v194, v195, 3, v194
    s_mul_i32 s63, s79, 96
    s_add_u32 s63, s63, s80
    s_lshl_b32 s63, s63, 7
    s_add_u32 s63, s63, 65536
    s_waitcnt vmcnt(14)
    v_lshlrev_b32 v208, 16, v192
    v_and_b32 v209, 0xffff0000, v192
    v_mul_f32 v206, 0xbfb8aa3b, v208
    v_mul_f32 v207, 0xbfb8aa3b, v209
    v_exp_f32 v206, v206
    v_exp_f32 v207, v207
    v_add_f32 v206, 1.0, v206
    v_add_f32 v207, 1.0, v207
    v_rcp_f32 v206, v206
    v_rcp_f32 v207, v207
    v_mul_f32 v206, v208, v206
    v_mul_f32 v207, v209, v207
    v_cvt_pk_bf16_f32 v206, v206, v206
    v_cvt_pk_bf16_f32 v207, v207, v207
    s_nop 0
    v_and_b32_dpp v196, v206, v204 quad_perm:[0,0,0,0] row_mask:0xf bank_mask:0xf
    v_and_b32_dpp v197, v206, v205 quad_perm:[0,0,0,0] row_mask:0xf bank_mask:0xf
    v_and_b32_dpp v198, v207, v204 quad_perm:[0,0,0,0] row_mask:0xf bank_mask:0xf
    v_and_b32_dpp v199, v207, v205 quad_perm:[0,0,0,0] row_mask:0xf bank_mask:0xf
    v_and_b32_dpp v200, v206, v204 quad_perm:[1,1,1,1] row_mask:0xf bank_mask:0xf
    v_and_b32_dpp v201, v206, v205 quad_perm:[1,1,1,1] row_mask:0xf bank_mask:0xf
    s_waitcnt vmcnt(13)
    v_mfma_f32_4x4x4_16b_bf16 v[212:215], v[196:197], v[160:161], 0
    v_and_b32_dpp v202, v207, v204 quad_perm:[1,1,1,1] row_mask:0xf bank_mask:0xf
    v_mfma_f32_4x4x4_16b_bf16 v[216:219], v[196:197], v[162:163], 0
    v_and_b32_dpp v203, v207, v205 quad_perm:[1,1,1,1] row_mask:0xf bank_mask:0xf
    s_waitcnt vmcnt(12)
    v_mfma_f32_4x4x4_16b_bf16 v[212:215], v[198:199], v[164:165], v[212:215]
    v_and_b32_dpp v196, v206, v204 quad_perm:[2,2,2,2] row_mask:0xf bank_mask:0xf
    v_mfma_f32_4x4x4_16b_bf16 v[216:219], v[198:199], v[166:167], v[216:219]
    v_and_b32_dpp v197, v206, v205 quad_perm:[2,2,2,2] row_mask:0xf bank_mask:0xf
    s_waitcnt vmcnt(11)
    v_mfma_f32_4x4x4_16b_bf16 v[212:215], v[200:201], v[168:169], v[212:215]
    v_and_b32_dpp v198, v207, v204 quad_perm:[2,2,2,2] row_mask:0xf bank_mask:0xf
    v_mfma_f32_4x4x4_16b_bf16 v[216:219], v[200:201], v[170:171], v[216:219]
    v_and_b32_dpp v199, v207, v205 quad_perm:[2,2,2,2] row_mask:0xf bank_mask:0xf
    s_waitcnt vmcnt(10)
    v_mfma_f32_4x4x4_16b_bf16 v[212:215], v[202:203], v[172:173], v[212:215]
    v_and_b32_dpp v200, v206, v204 quad_perm:[3,3,3,3] row_mask:0xf bank_mask:0xf
    v_mfma_f32_4x4x4_16b_bf16 v[216:219], v[202:203], v[174:175], v[216:219]
    v_and_b32_dpp v201, v206, v205 quad_perm:[3,3,3,3] row_mask:0xf bank_mask:0xf
    s_waitcnt vmcnt(9)
    v_mfma_f32_4x4x4_16b_bf16 v[212:215], v[196:197], v[176:177], v[212:215]
    v_and_b32_dpp v202, v207, v204 quad_perm:[3,3,3,3] row_mask:0xf bank_mask:0xf
    v_mfma_f32_4x4x4_16b_bf16 v[216:219], v[196:197], v[178:179], v[216:219]
    v_and_b32_dpp v203, v207, v205 quad_perm:[3,3,3,3] row_mask:0xf bank_mask:0xf
    s_waitcnt vmcnt(8)
    v_mfma_f32_4x4x4_16b_bf16 v[212:215], v[198:199], v[180:181], v[212:215]
    v_mfma_f32_4x4x4_16b_bf16 v[216:219], v[198:199], v[182:183], v[216:219]
    s_waitcnt vmcnt(7)
    v_mfma_f32_4x4x4_16b_bf16 v[212:215], v[200:201], v[184:185], v[212:215]
    v_mfma_f32_4x4x4_16b_bf16 v[216:219], v[200:201], v[186:187], v[216:219]
    s_waitcnt vmcnt(6)
    v_mfma_f32_4x4x4_16b_bf16 v[212:215], v[202:203], v[188:189], v[212:215]
    v_mfma_f32_4x4x4_16b_bf16 v[216:219], v[202:203], v[190:191], v[216:219]
    s_nop 4
    v_permlane32_swap_b32 v212, v216
    v_permlane32_swap_b32 v213, v217
    v_permlane32_swap_b32 v214, v218
    v_permlane32_swap_b32 v215, v219
    v_add_f32 v212, v212, v216
    v_add_f32 v213, v213, v217
    v_add_f32 v214, v214, v218
    v_add_f32 v215, v215, v219
    s_nop 0
    v_permlane16_swap_b32 v212, v214
    v_permlane16_swap_b32 v213, v215
    v_add_f32 v212, v212, v214
    v_add_f32 v213, v213, v215
    s_nop 0
    v_add_f32_dpp v212, v212, v212 row_ror:8 row_mask:0xf bank_mask:0xf
    v_add_f32_dpp v213, v213, v213 row_ror:8 row_mask:0xf bank_mask:0xf
    s_nop 0
    v_add_f32_dpp v212, v212, v212 row_ror:4 row_mask:0xf bank_mask:0xf
    v_add_f32_dpp v213, v213, v213 row_ror:4 row_mask:0xf bank_mask:0xf
    v_add_u32 v212, 0x80, v212
    v_add_u32 v213, 0x80, v213
    v_bfi_b32 v212, v193, v210, v212
    v_bfi_b32 v213, v193, v211, v213
    s_mov_b32 exec_lo, 0xf000f
    s_mov_b32 exec_hi, 0xf000f
    buffer_store_dwordx2 v[212:213], v194, s[52:55], s63 offen sc1
    s_mov_b64 exec, -1
    s_waitcnt vmcnt(5)
    s_branch L_xok_3
L_pret:
    s_setpc_b64 s[84:85]
L_skip_5:
    s_waitcnt vmcnt(4)
L_xok_3:
    v_lshlrev_b32 v60, 16, v96
    v_and_b32 v61, 0xffff0000, v96
    v_lshlrev_b32 v62, 16, v97
    v_and_b32 v63, 0xffff0000, v97
    v_lshlrev_b32 v64, 16, v98
    v_and_b32 v65, 0xffff0000, v98
    v_lshlrev_b32 v66, 16, v99
    v_and_b32 v67, 0xffff0000, v99
    v_lshlrev_b32 v68, 16, v100
    v_and_b32 v69, 0xffff0000, v100
    v_lshlrev_b32 v70, 16, v101
    v_and_b32 v71, 0xffff0000, v101
    v_lshlrev_b32 v72, 16, v102
    v_and_b32 v73, 0xffff0000, v102
    v_lshlrev_b32 v74, 16, v103
    v_and_b32 v75, 0xffff0000, v103
    v_pk_add_f32 v[76:77], v[60:61], v[62:63]
    v_pk_mul_f32 v[78:79], v[60:61], v[60:61]
    v_pk_fma_f32 v[78:79], v[62:63], v[62:63], v[78:79]
    v_pk_add_f32 v[76:77], v[76:77], v[64:65]
    v_pk_fma_f32 v[78:79], v[64:65], v[64:65], v[78:79]
    v_pk_add_f32 v[76:77], v[76:77], v[66:67]
    v_pk_fma_f32 v[78:79], v[66:67], v[66:67], v[78:79]
    v_pk_add_f32 v[76:77], v[76:77], v[68:69]
    v_pk_fma_f32 v[78:79], v[68:69], v[68:69], v[78:79]
    v_pk_add_f32 v[76:77], v[76:77], v[70:71]
    v_pk_fma_f32 v[78:79], v[70:71], v[70:71], v[78:79]
    v_pk_add_f32 v[76:77], v[76:77], v[72:73]
    v_pk_fma_f32 v[78:79], v[72:73], v[72:73], v[78:79]
    v_pk_add_f32 v[76:77], v[76:77], v[74:75]
    v_pk_fma_f32 v[78:79], v[74:75], v[74:75], v[78:79]
    v_add_f32 v76, v76, v77
    v_add_f32 v77, v78, v79
    v_and_b32 v80, 7, v1
    v_lshlrev_b32 v80, 5, v80
    v_permlane32_swap_b32 v76, v77
    v_add_f32 v76, v76, v77
    v_mov_b32 v77, v76
    v_add_u32 v80, 136192, v80
    v_lshrrev_b32 v81, 5, v1
    v_permlane16_swap_b32 v76, v77
    v_add_f32 v76, v76, v77
    v_lshl_add_u32 v81, v81, 2, s62
    v_lshl_add_u32 v81, v81, 2, v80
    v_add_f32_dpp v76, v76, v76 row_ror:8 row_mask:0xf bank_mask:0xf
    ds_write_b32 v81, v76
    s_waitcnt lgkmcnt(0)
    s_barrier
    ds_read_b128 v[84:87], v80
    ds_read_b128 v[88:91], v80 offset:16
    s_lshr_b32 s24, s2, 3
    s_lshl2_add_u32 s24, s24, s62
    v_and_b32 v254, 3, v1
    s_lshl_b32 s24, s24, 12
    v_lshlrev_b32 v254, 10, v254
    buffer_load_dword v255, v254, s[20:23], s24 offen offset:384
    s_lshr_b32 s24, s2, 3
    s_lshl2_add_u32 s24, s24, s62
    s_mul_i32 s24, s24, 12288
    v_and_b32 v254, 15, v1
    v_min_u32 v254, 11, v254
    v_lshlrev_b32 v254, 10, v254
    buffer_load_dword v255, v254, s[12:15], s24 offen offset:384
    s_lshl2_add_u32 s24, s61, s62
    s_lshl_b32 s24, s24, 11
    v_and_b32 v253, 15, v1
    v_lshl_add_u32 v253, v253, 7, s24
    s_mov_b32 s25, 131072
    s_lshl_b32 s24, s60, 17
    buffer_load_dword v255, v253, s[44:47], s24 offen sc1
    s_lshl1_add_u32 m0, s5, 39936
    s_mul_i32 s84, s3, 48
    buffer_load_dwordx4 v3, s[12:15], s84 offen offset:1024 lds
    buffer_load_dwordx4 v3, s[12:15], s84 offen offset:2048 lds
    s_waitcnt lgkmcnt(1)
    v_pk_add_f32 v[84:85], v[84:85], v[86:87]
    s_waitcnt lgkmcnt(0)
    v_pk_add_f32 v[88:89], v[88:89], v[90:91]
    v_add_f32 v76, v84, v85
    v_add_f32 v77, v88, v89
    v_mul_f32 v76, 0x3b000000, v76
    v_mul_f32 v77, 0x3b000000, v77
    v_fma_f32 v77, -v76, v76, v77
    v_max_f32 v77, 0, v77
    v_add_f32 v77, 0x3727c5ac, v77
    v_rsq_f32 v78, v77
    v_mul_f32 v76, -1.0, v76
    v_mul_f32 v76, v76, v78
    v_pk_fma_f32 v[60:61], v[60:61], v[78:79], v[76:77] op_sel_hi:[1,0,0]
    v_pk_fma_f32 v[62:63], v[62:63], v[78:79], v[76:77] op_sel_hi:[1,0,0]
    v_pk_fma_f32 v[64:65], v[64:65], v[78:79], v[76:77] op_sel_hi:[1,0,0]
    v_pk_fma_f32 v[66:67], v[66:67], v[78:79], v[76:77] op_sel_hi:[1,0,0]
    v_pk_fma_f32 v[68:69], v[68:69], v[78:79], v[76:77] op_sel_hi:[1,0,0]
    v_pk_fma_f32 v[70:71], v[70:71], v[78:79], v[76:77] op_sel_hi:[1,0,0]
    v_pk_fma_f32 v[72:73], v[72:73], v[78:79], v[76:77] op_sel_hi:[1,0,0]
    v_pk_fma_f32 v[74:75], v[74:75], v[78:79], v[76:77] op_sel_hi:[1,0,0]
    s_add_u32 s63, s5, 137216
    v_add_u32 v80, s63, v2
    v_and_b32 v81, 0x38, v1
    v_lshl_add_u32 v81, v81, 2, s63
    s_lshr_b32 s63, s71, 9
    s_lshl_b32 s63, s63, 15
    s_and_b32 s64, s61, 3
    s_lshl_b32 s64, s64, 7
    s_add_u32 s63, s63, s64
    s_lshl3_add_u32 s63, s5, s63
    v_add_u32 v20, s63, v20
    s_movk_i32 s63, 4096
    s_movk_i32 s64, 12288
    s_movk_i32 s65, 24576
    s_mov_b32 s66, 36864
    s_mov_b32 s67, 0
    s_cmp_lg_u32 s81, 2
    s_cbranch_scc1 L_skip_6
    s_mov_b64 vcc, 0xffff
    v_lshlrev_b32 v208, 4, v1
    v_and_b32 v210, 16, v1
    v_lshlrev_b64 v[204:205], v208, vcc
    v_lshrrev_b32 v210, v210, s72
    v_mov_b32 v193, 0xff
    v_lshrrev_b32 v211, 8, v210
    s_waitcnt vmcnt(13)
    v_lshlrev_b32 v208, 16, v192
    v_and_b32 v209, 0xffff0000, v192
    v_mul_f32 v206, 0xbfb8aa3b, v208
    v_mul_f32 v207, 0xbfb8aa3b, v209
    v_exp_f32 v206, v206
    v_exp_f32 v207, v207
    v_add_f32 v206, 1.0, v206
    v_add_f32 v207, 1.0, v207
    v_rcp_f32 v206, v206
    v_rcp_f32 v207, v207
    v_mul_f32 v206, v208, v206
    v_mul_f32 v207, v209, v207
    v_cvt_pk_bf16_f32 v206, v206, v206
    v_cvt_pk_bf16_f32 v207, v207, v207
    s_nop 0
    v_and_b32_dpp v196, v206, v204 quad_perm:[0,0,0,0] row_mask:0xf bank_mask:0xf
    v_and_b32_dpp v197, v206, v205 quad_perm:[0,0,0,0] row_mask:0xf bank_mask:0xf
    v_and_b32_dpp v198, v207, v204 quad_perm:[0,0,0,0] row_mask:0xf bank_mask:0xf
    v_and_b32_dpp v199, v207, v205 quad_perm:[0,0,0,0] row_mask:0xf bank_mask:0xf
    v_and_b32_dpp v200, v206, v204 quad_perm:[1,1,1,1] row_mask:0xf bank_mask:0xf
    v_and_b32_dpp v201, v206, v205 quad_perm:[1,1,1,1] row_mask:0xf bank_mask:0xf
    s_waitcnt vmcnt(12)
    v_mfma_f32_4x4x4_16b_bf16 v[212:215], v[196:197], v[160:161], 0
    v_and_b32_dpp v202, v207, v204 quad_perm:[1,1,1,1] row_mask:0xf bank_mask:0xf
    v_mfma_f32_4x4x4_16b_bf16 v[216:219], v[196:197], v[162:163], 0
    v_and_b32_dpp v203, v207, v205 quad_perm:[1,1,1,1] row_mask:0xf bank_mask:0xf
    s_waitcnt vmcnt(11)
    v_mfma_f32_4x4x4_16b_bf16 v[212:215], v[198:199], v[164:165], v[212:215]
    v_and_b32_dpp v196, v206, v204 quad_perm:[2,2,2,2] row_mask:0xf bank_mask:0xf
    v_mfma_f32_4x4x4_16b_bf16 v[216:219], v[198:199], v[166:167], v[216:219]
    v_and_b32_dpp v197, v206, v205 quad_perm:[2,2,2,2] row_mask:0xf bank_mask:0xf
    s_waitcnt vmcnt(10)
    v_mfma_f32_4x4x4_16b_bf16 v[212:215], v[200:201], v[168:169], v[212:215]
    v_and_b32_dpp v198, v207, v204 quad_perm:[2,2,2,2] row_mask:0xf bank_mask:0xf
    v_mfma_f32_4x4x4_16b_bf16 v[216:219], v[200:201], v[170:171], v[216:219]
    v_and_b32_dpp v199, v207, v205 quad_perm:[2,2,2,2] row_mask:0xf bank_mask:0xf
    s_waitcnt vmcnt(9)
    v_mfma_f32_4x4x4_16b_bf16 v[212:215], v[202:203], v[172:173], v[212:215]
    v_and_b32_dpp v200, v206, v204 quad_perm:[3,3,3,3] row_mask:0xf bank_mask:0xf
    v_mfma_f32_4x4x4_16b_bf16 v[216:219], v[202:203], v[174:175], v[216:219]
    v_and_b32_dpp v201, v206, v205 quad_perm:[3,3,3,3] row_mask:0xf bank_mask:0xf
    s_waitcnt vmcnt(8)
    v_mfma_f32_4x4x4_16b_bf16 v[212:215], v[196:197], v[176:177], v[212:215]
    v_and_b32_dpp v202, v207, v204 quad_perm:[3,3,3,3] row_mask:0xf bank_mask:0xf
    v_mfma_f32_4x4x4_16b_bf16 v[216:219], v[196:197], v[178:179], v[216:219]
    v_and_b32_dpp v203, v207, v205 quad_perm:[3,3,3,3] row_mask:0xf bank_mask:0xf
    s_waitcnt vmcnt(7)
    v_mfma_f32_4x4x4_16b_bf16 v[212:215], v[198:199], v[180:181], v[212:215]
    v_mfma_f32_4x4x4_16b_bf16 v[216:219], v[198:199], v[182:183], v[216:219]
    s_waitcnt vmcnt(6)
    v_mfma_f32_4x4x4_16b_bf16 v[212:215], v[200:201], v[184:185], v[212:215]
    v_mfma_f32_4x4x4_16b_bf16 v[216:219], v[200:201], v[186:187], v[216:219]
    s_waitcnt vmcnt(5)
    v_mfma_f32_4x4x4_16b_bf16 v[212:215], v[202:203], v[188:189], v[212:215]
    v_mfma_f32_4x4x4_16b_bf16 v[216:219], v[202:203], v[190:191], v[216:219]
    s_nop 4
    v_permlane32_swap_b32 v212, v216
    v_permlane32_swap_b32 v213, v217
    v_permlane32_swap_b32 v214, v218
    v_permlane32_swap_b32 v215, v219
    v_add_f32 v212, v212, v216
    v_add_f32 v213, v213, v217
    v_add_f32 v214, v214, v218
    v_add_f32 v215, v215, v219
    s_nop 0
    v_permlane16_swap_b32 v212, v214
    v_permlane16_swap_b32 v213, v215
    v_add_f32 v212, v212, v214
    v_add_f32 v213, v213, v215
    s_nop 0
    v_add_f32_dpp v212, v212, v212 row_ror:8 row_mask:0xf bank_mask:0xf
    v_add_f32_dpp v213, v213, v213 row_ror:8 row_mask:0xf bank_mask:0xf
    s_nop 0
    v_add_f32_dpp v212, v212, v212 row_ror:4 row_mask:0xf bank_mask:0xf
    v_add_f32_dpp v213, v213, v213 row_ror:4 row_mask:0xf bank_mask:0xf
    v_add_u32 v212, 0x80, v212
    v_add_u32 v213, 0x80, v213
    v_bfi_b32 v212, v193, v210, v212
    v_bfi_b32 v213, v193, v211, v213
L_skip_6:
    s_mov_b64 exec, 0
    s_cmp_lg_u32 s62, 1
    s_cbranch_scc1 L_ptn_8
    s_call_b64 s[84:85], L_page_1
    s_branch L_ptd_7
L_ptn_8:
    s_cmp_lg_u32 s62, 3
    s_cbranch_scc1 L_ptn_9
    s_call_b64 s[84:85], L_page_2
L_ptn_9:
L_ptd_7:
    s_mov_b64 exec, -1
    s_waitcnt vmcnt(0)
    buffer_load_dwordx4 v[100:103], v93, s[52:55], 0 offen sc1
    buffer_load_dwordx4 v[104:107], v93, s[52:55], s64 offen sc1
    buffer_load_dwordx4 v[108:111], v93, s[52:55], s65 offen sc1
    buffer_load_dwordx4 v[112:115], v93, s[52:55], s66 offen sc1
    s_mov_b64 exec, 0xffff
    buffer_load_dword v252, v18, s[52:55], 0 offen offset:4 sc1
    s_mov_b64 exec, -1
    s_lshl1_add_u32 m0, s5, 48128
    s_mul_i32 s84, s6, 48
    buffer_load_dwordx4 v3, s[12:15], s84 offen offset:1024 lds
    buffer_load_dwordx4 v3, s[12:15], s84 offen offset:2048 lds
    s_lshl1_add_u32 m0, s5, 56320
    s_mul_i32 s84, s7, 48
    buffer_load_dwordx4 v3, s[12:15], s84 offen offset:1024 lds
    buffer_load_dwordx4 v3, s[12:15], s84 offen offset:2048 lds
    s_waitcnt vmcnt(8)
    v_xor_b32 v100, s48, v100
    v_xor_b32 v101, s49, v101
    v_xor_b32 v102, s50, v102
    v_xor_b32 v103, s51, v103
    s_waitcnt vmcnt(7)
    v_xor_b32 v104, s48, v104
    v_xor_b32 v105, s49, v105
    v_xor_b32 v106, s50, v106
    v_xor_b32 v107, s51, v107
    s_waitcnt vmcnt(6)
    v_xor_b32 v108, s48, v108
    v_xor_b32 v109, s49, v109
    v_xor_b32 v110, s50, v110
    v_xor_b32 v111, s51, v111
    s_waitcnt vmcnt(5)
    v_xor_b32 v112, s48, v112
    v_xor_b32 v113, s49, v113
    v_xor_b32 v114, s50, v114
    v_xor_b32 v115, s51, v115
    v_or3_b32 v76, v100, v101, v102
    v_or3_b32 v77, v103, v104, v105
    v_or3_b32 v76, v76, v106, v107
    v_or3_b32 v77, v77, v108, v109
    v_or3_b32 v76, v76, v110, v111
    v_or3_b32 v77, v77, v112, v113
    v_or3_b32 v76, v76, v114, v115
    v_or_b32 v76, v76, v77
    v_and_b32 v76, 0xff, v76
    v_cmp_ne_u32 vcc, 0, v76
    s_cbranch_vccz L_rtok_11
    s_mov_b32 s67, 0
L_rt_10:
    buffer_load_dwordx4 v[100:103], v93, s[52:55], 0 offen sc1
    buffer_load_dwordx4 v[104:107], v93, s[52:55], s64 offen sc1
    buffer_load_dwordx4 v[108:111], v93, s[52:55], s65 offen sc1
    buffer_load_dwordx4 v[112:115], v93, s[52:55], s66 offen sc1
    s_add_u32 s67, s67, 1
    s_waitcnt vmcnt(0)
    v_xor_b32 v100, s48, v100
    v_xor_b32 v101, s49, v101
    v_xor_b32 v102, s50, v102
    v_xor_b32 v103, s51, v103
    v_xor_b32 v104, s48, v104
    v_xor_b32 v105, s49, v105
    v_xor_b32 v106, s50, v106
    v_xor_b32 v107, s51, v107
    v_xor_b32 v108, s48, v108
    v_xor_b32 v109, s49, v109
    v_xor_b32 v110, s50, v110
    v_xor_b32 v111, s51, v111
    v_xor_b32 v112, s48, v112
    v_xor_b32 v113, s49, v113
    v_xor_b32 v114, s50, v114
    v_xor_b32 v115, s51, v115
    v_or3_b32 v76, v100, v101, v102
L_page_1:
    s_cbranch_execz L_page_3
    v_or3_b32 v77, v103, v104, v105
    v_or3_b32 v76, v76, v106, v107
    v_or3_b32 v77, v77, v108, v109
    v_or3_b32 v76, v76, v110, v111
    v_or3_b32 v77, v77, v112, v113
    v_or3_b32 v76, v76, v114, v115
    v_or_b32 v76, v76, v77
    v_and_b32 v76, 0xff, v76
    v_cmp_ne_u32 vcc, 0, v76
    s_cbranch_vccz L_rtok_11
    s_cmp_lt_u32 s67, 20000
    s_cbranch_scc1 L_rt_10
L_rtok_11:
    v_pk_add_f32 v[100:101], v[100:101], v[104:105]
    v_pk_add_f32 v[108:109], v[108:109], v[112:113]
    v_pk_add_f32 v[102:103], v[102:103], v[106:107]
    v_pk_add_f32 v[110:111], v[110:111], v[114:115]
    v_pk_add_f32 v[100:101], v[100:101], v[108:109]
    v_pk_add_f32 v[102:103], v[102:103], v[110:111]
    v_cvt_pk_bf16_f32 v100, 0, v100
    v_cvt_pk_bf16_f32 v101, 0, v101
    v_cvt_pk_bf16_f32 v102, 0, v102
    v_cvt_pk_bf16_f32 v103, 0, v103
    v_add_f32 v100, v94, v100
    v_add_f32 v101, v94, v101
    v_add_f32 v102, v94, v102
    v_add_f32 v103, v94, v103
    v_cvt_pk_bf16_f32 v100, 0, v100
    v_cvt_pk_bf16_f32 v101, 0, v101
    v_cvt_pk_bf16_f32 v102, 0, v102
    v_cvt_pk_bf16_f32 v103, 0, v103
    ds_write_b128 v80, v[100:103]
    ds_read_b128 v[116:119], v81 offset:0
    ds_read_b128 v[120:123], v81 offset:16
    ds_read_b128 v[132:135], v81 offset:512
    ds_read_b128 v[136:139], v81 offset:528
    ds_read_b128 v[124:127], v81 offset:256
    ds_read_b128 v[128:131], v81 offset:272
    ds_read_b128 v[140:143], v81 offset:768
    ds_read_b128 v[144:147], v81 offset:784
    s_waitcnt vmcnt(4)
    v_cmp_ne_u32 vcc, s28, v252
    s_and_b32 s28, vcc_lo, 0xffff
    s_cselect_b32 s29, 2, 0
    s_cmp_lg_u32 s62, 0
    s_cselect_b32 s29, 1, s29
    s_waitcnt lgkmcnt(5)
    v_pk_fma_f32 v[60:61], v[60:61], v[132:133], v[116:117]
    v_pk_fma_f32 v[62:63], v[62:63], v[134:135], v[118:119]
    s_waitcnt lgkmcnt(4)
    v_pk_fma_f32 v[64:65], v[64:65], v[136:137], v[120:121]
    v_pk_fma_f32 v[66:67], v[66:67], v[138:139], v[122:123]
    v_cvt_pk_bf16_f32 v100, v60, v61
    v_cvt_pk_bf16_f32 v101, v62, v63
    v_cvt_pk_bf16_f32 v102, v64, v65
    v_cvt_pk_bf16_f32 v103, v66, v67
    s_cmp_lg_u32 s28, 0
    s_cbranch_scc1 L_far_12
    buffer_store_dwordx4 v[100:103], v20, s[44:47], 0 offen
L_back_13:
    s_waitcnt lgkmcnt(1)
    v_pk_fma_f32 v[68:69], v[68:69], v[140:141], v[124:125]
    v_pk_fma_f32 v[70:71], v[70:71], v[142:143], v[126:127]
    s_waitcnt lgkmcnt(0)
    v_pk_fma_f32 v[72:73], v[72:73], v[144:145], v[128:129]
    v_pk_fma_f32 v[74:75], v[74:75], v[146:147], v[130:131]
    v_cvt_pk_bf16_f32 v104, v68, v69
    v_cvt_pk_bf16_f32 v105, v70, v71
    v_cvt_pk_bf16_f32 v106, v72, v73
    v_cvt_pk_bf16_f32 v107, v74, v75
    s_cbranch_scc1 L_far_14
    buffer_store_dwordx4 v[104:107], v20, s[44:47], s63 offen
L_back_15:
    s_lshl1_add_u32 m0, s5, 64512
    s_mul_i32 s84, s26, 48
    buffer_load_dwordx4 v3, s[12:15], s84 offen offset:1024 lds
    buffer_load_dwordx4 v3, s[12:15], s84 offen offset:2048 lds
    s_lshl1_add_u32 m0, s5, 72704
    s_mul_i32 s84, s27, 48
    buffer_load_dwordx4 v3, s[12:15], s84 offen offset:1024 lds
    buffer_load_dwordx4 v3, s[12:15], s84 offen offset:2048 lds
    s_cmp_lg_u32 s81, 2
    s_cbranch_scc1 L_skip_16
    v_and_b32 v194, 3, v1
    v_lshlrev_b32 v194, 5, v194
    v_lshrrev_b32 v195, 4, v1
    v_lshl_add_u32 v194, v195, 3, v194
    s_mul_i32 s63, s79, 96
    s_add_u32 s63, s63, s80
    s_lshl_b32 s63, s63, 7
    s_add_u32 s63, s63, 65536
    s_mov_b32 exec_lo, 0xf000f
    s_mov_b32 exec_hi, 0xf000f
    buffer_store_dwordx2 v[212:213], v194, s[52:55], s63 offen sc1
    s_mov_b64 exec, -1
L_skip_16:
    s_add_u32 s75, s72, 1
    v_mov_b32 v21, s75
    s_cmp_lg_u32 s29, 0
    s_waitcnt vmcnt(4)
    s_barrier
    s_cbranch_scc1 L_sig_17
    s_mov_b64 exec, 1
    buffer_store_dword v21, off, s[52:55], s71
    s_mov_b64 exec, -1
L_sig_17:
    s_cmp_eq_u32 s29, 2
    s_cbranch_scc1 L_far_18
L_back_19:
    s_lshl1_add_u32 m0, s5, 80896
    s_mul_i32 s84, s30, 48
    buffer_load_dwordx4 v3, s[12:15], s84 offen offset:1024 lds
    buffer_load_dwordx4 v3, s[12:15], s84 offen offset:2048 lds
    s_lshl1_add_u32 m0, s5, 89088
    s_mul_i32 s84, s31, 48
    buffer_load_dwordx4 v3, s[12:15], s84 offen offset:1024 lds
    buffer_load_dwordx4 v3, s[12:15], s84 offen offset:2048 lds
    ds_read_b64_tr_b16 v[100:101], v92 offset:0
    ds_read_b64_tr_b16 v[102:103], v92 offset:256
    ds_read_b64_tr_b16 v[104:105], v92 offset:512
    ds_read_b64_tr_b16 v[106:107], v92 offset:768
    ds_read_b64_tr_b16 v[164:165], v9 offset:0
    ds_read_b64_tr_b16 v[166:167], v9 offset:256
    ds_read_b64_tr_b16 v[168:169], v9 offset:1024
    ds_read_b64_tr_b16 v[170:171], v9 offset:1280
    ds_read_b64_tr_b16 v[172:173], v9 offset:2048
    ds_read_b64_tr_b16 v[174:175], v9 offset:2304
    ds_read_b64_tr_b16 v[176:177], v9 offset:3072
    ds_read_b64_tr_b16 v[178:179], v9 offset:3328
    ds_read_b64_tr_b16 v[180:181], v9 offset:4096
    ds_read_b64_tr_b16 v[182:183], v9 offset:4352
    ds_read_b64_tr_b16 v[184:185], v9 offset:5120
    ds_read_b64_tr_b16 v[186:187], v9 offset:5376
    ds_read_b64_tr_b16 v[188:189], v9 offset:6144
    ds_read_b64_tr_b16 v[190:191], v9 offset:6400
    ds_read_b64_tr_b16 v[192:193], v9 offset:7168
    ds_read_b64_tr_b16 v[194:195], v9 offset:7424
    ds_read_b64_tr_b16 v[196:197], v9 offset:8192
    ds_read_b64_tr_b16 v[198:199], v9 offset:8448
    ds_read_b64_tr_b16 v[200:201], v9 offset:9216
    ds_read_b64_tr_b16 v[202:203], v9 offset:9472
    ds_read_b64_tr_b16 v[204:205], v9 offset:10240
    ds_read_b64_tr_b16 v[206:207], v9 offset:10496
    ds_read_b64_tr_b16 v[208:209], v9 offset:11264
    ds_read_b64_tr_b16 v[210:211], v9 offset:11520
    ds_read_b64_tr_b16 v[212:213], v9 offset:12288
    ds_read_b64_tr_b16 v[214:215], v9 offset:12544
    ds_read_b64_tr_b16 v[216:217], v9 offset:13312
    ds_read_b64_tr_b16 v[218:219], v9 offset:13568
    ds_read_b64_tr_b16 v[220:221], v9 offset:14336
    ds_read_b64_tr_b16 v[222:223], v9 offset:14592
    ds_read_b64_tr_b16 v[224:225], v9 offset:15360
    ds_read_b64_tr_b16 v[226:227], v9 offset:15616
    ds_read_b64_tr_b16 v[228:229], v8 offset:0
    ds_read_b64_tr_b16 v[230:231], v8 offset:256
    ds_read_b64_tr_b16 v[232:233], v9 offset:16384
    ds_read_b64_tr_b16 v[234:235], v9 offset:16640
    v_bfe_u32 v60, v1, 2, 1
    s_mov_b32 s63, 0x80008000
    v_mul_lo_u32 v61, v60, s63
    v_lshrrev_b32 v62, 5, v1
    v_bfe_u32 v63, v1, 3, 2
    v_bfe_u32 v64, v1, 1, 1
    v_lshl_add_u32 v63, v63, 1, v64
    v_xor_b32 v62, v62, v60
    v_lshl_add_u32 v63, v62, 3, v63
    v_and_b32 v64, 1, v1
    v_lshlrev_b32 v64, 4, v64
    v_lshlrev_b32 v64, v64, s68
    s_lshl_b32 s63, s62, 9
    v_add_u32 v66, s63, v18
    s_lshl2_add_u32 s63, s60, s62
    s_lshl_b32 s63, s63, 15
    v_add_u32 v67, s63, v2
    s_mov_b64 exec, 15
    s_mov_b32 s67, 0
    s_add_u32 s75, s72, 1
L_poll_20:
    buffer_load_dword v65, v66, s[52:55], 0 offen sc1
    s_add_u32 s67, s67, 1
    s_waitcnt vmcnt(0)
    v_subrev_u32 v65, s75, v65
    v_cmp_lt_u32 vcc, 5, v65
    s_cbranch_vccz L_polld_21
    s_cmp_lt_u32 s67, 20000
    s_cbranch_scc1 L_poll_20
L_polld_21:
    s_mov_b64 exec, -1
    buffer_load_dwordx4 a[0:3], v67, s[44:47], s73 offen offset:0 sc1
    buffer_load_dwordx4 a[4:7], v67, s[44:47], s73 offen offset:1024 sc1
    buffer_load_dwordx4 a[8:11], v67, s[44:47], s73 offen offset:2048 sc1
    buffer_load_dwordx4 a[12:15], v67, s[44:47], s73 offen offset:3072 sc1
    buffer_load_dwordx4 a[16:19], v67, s[44:47], s3 offen offset:0 sc1
    buffer_load_dwordx4 a[20:23], v67, s[44:47], s3 offen offset:1024 sc1
    buffer_load_dwordx4 a[24:27], v67, s[44:47], s3 offen offset:2048 sc1
    buffer_load_dwordx4 a[28:31], v67, s[44:47], s3 offen offset:3072 sc1
    buffer_load_dwordx4 a[32:35], v67, s[44:47], s6 offen offset:0 sc1
    s_barrier
    v_cmp_eq_u32 vcc, 0, v63
    v_mov_b32 v116, 0
    v_mov_b32 v117, 0
    v_cndmask_b32 v108, 0, v64, vcc
    v_cmp_eq_u32 vcc, 1, v63
    v_mov_b32 v118, 0
    v_mov_b32 v119, 0
    v_cndmask_b32 v109, 0, v64, vcc
    v_cmp_eq_u32 vcc, 2, v63
    v_mov_b32 v120, 0
    v_mov_b32 v121, 0
    v_cndmask_b32 v110, 0, v64, vcc
    v_cmp_eq_u32 vcc, 3, v63
    v_mov_b32 v122, 0
    v_mov_b32 v123, 0
    v_cndmask_b32 v111, 0, v64, vcc
    v_cmp_eq_u32 vcc, 4, v63
    v_mov_b32 v124, 0
    v_mov_b32 v125, 0
    v_cndmask_b32 v112, 0, v64, vcc
    v_cmp_eq_u32 vcc, 5, v63
    v_mov_b32 v126, 0
    v_mov_b32 v127, 0
    v_cndmask_b32 v113, 0, v64, vcc
    v_cmp_eq_u32 vcc, 6, v63
    v_mov_b32 v128, 0
    v_mov_b32 v129, 0
    v_cndmask_b32 v114, 0, v64, vcc
    v_cmp_eq_u32 vcc, 7, v63
    v_mov_b32 v130, 0
    v_mov_b32 v131, 0
    v_cndmask_b32 v115, 0, v64, vcc
    s_waitcnt lgkmcnt(15)
    v_xor_b32 v100, v100, v61
    v_xor_b32 v101, v101, v61
    v_xor_b32 v102, v102, v61
    v_xor_b32 v103, v103, v61
    v_xor_b32 v104, v104, v61
    v_xor_b32 v105, v105, v61
    v_xor_b32 v106, v106, v61
    v_xor_b32 v107, v107, v61
    s_lshl2_add_u32 s63, s62, 141312
    v_add_u32 v86, s63, v2
    s_lshl2_add_u32 s63, s5, 143360
    v_add_u32 v87, s63, v2
    s_add_u32 s63, s5, 143360
    v_add_u32 v88, s63, v2
    v_add_u32 v89, 141312, v2
    s_lshl4_add_u32 s79, s61, s60
    s_mul_i32 s79, s79, 2304
    s_add_u32 s79, s79, 262144
    s_lshl_b32 s80, s62, 9
    s_add_u32 s80, s80, s79
    v_lshlrev_b32 v90, 3, v1
    v_lshlrev_b32 v91, 2, v1
    s_waitcnt vmcnt(8)
    v_mfma_f32_32x32x16_bf16 v[132:147], v[164:167], a[0:3], 0
    ds_read_b64_tr_b16 v[236:237], v9 offset:17408
    ds_read_b64_tr_b16 v[238:239], v9 offset:17664
    buffer_load_dwordx4 a[36:39], v67, s[44:47], s6 offen offset:1024 sc1
    v_mfma_f32_32x32x16_bf16 v[148:163], a[0:3], v[168:171], 0
    ds_read_b64_tr_b16 v[240:241], v9 offset:18432
    ds_read_b64_tr_b16 v[242:243], v9 offset:18688
    s_waitcnt vmcnt(8)
    v_mfma_f32_32x32x16_bf16 v[132:147], v[172:175], a[4:7], v[132:147]
    ds_read_b64_tr_b16 v[244:245], v9 offset:19456
    ds_read_b64_tr_b16 v[246:247], v9 offset:19712
    buffer_load_dwordx4 a[40:43], v67, s[44:47], s6 offen offset:2048 sc1
    v_mfma_f32_32x32x16_bf16 v[148:163], a[4:7], v[176:179], v[148:163]
    ds_read_b64_tr_b16 v[248:249], v9 offset:20480
    ds_read_b64_tr_b16 v[250:251], v9 offset:20736
    s_waitcnt vmcnt(8)
    v_mfma_f32_32x32x16_bf16 v[132:147], v[180:183], a[8:11], v[132:147]
    ds_read_b64_tr_b16 v[164:165], v9 offset:21504
    ds_read_b64_tr_b16 v[166:167], v9 offset:21760
    buffer_load_dwordx4 a[44:47], v67, s[44:47], s6 offen offset:3072 sc1
    v_mfma_f32_32x32x16_bf16 v[148:163], a[8:11], v[184:187], v[148:163]
    ds_read_b64_tr_b16 v[168:169], v9 offset:22528
    ds_read_b64_tr_b16 v[170:171], v9 offset:22784
    s_waitcnt vmcnt(8)
    v_mfma_f32_32x32x16_bf16 v[132:147], v[188:191], a[12:15], v[132:147]
    ds_read_b64_tr_b16 v[172:173], v9 offset:23552
    ds_read_b64_tr_b16 v[174:175], v9 offset:23808
    buffer_load_dwordx4 a[48:51], v67, s[44:47], s7 offen offset:0 sc1
    v_mfma_f32_32x32x16_bf16 v[148:163], a[12:15], v[192:195], v[148:163]
    ds_read_b64_tr_b16 v[176:177], v9 offset:24576
    ds_read_b64_tr_b16 v[178:179], v9 offset:24832
    s_waitcnt vmcnt(8)
    v_mfma_f32_32x32x16_bf16 v[132:147], v[196:199], a[16:19], v[132:147]
    ds_read_b64_tr_b16 v[180:181], v9 offset:25600
    ds_read_b64_tr_b16 v[182:183], v9 offset:25856
    buffer_load_dwordx4 a[52:55], v67, s[44:47], s7 offen offset:1024 sc1
    v_mfma_f32_32x32x16_bf16 v[148:163], a[16:19], v[200:203], v[148:163]
    ds_read_b64_tr_b16 v[184:185], v9 offset:26624
    ds_read_b64_tr_b16 v[186:187], v9 offset:26880
    s_waitcnt vmcnt(8) lgkmcnt(8)
    v_mfma_f32_32x32x16_bf16 v[132:147], v[204:207], a[20:23], v[132:147]
    ds_read_b64_tr_b16 v[188:189], v9 offset:27648
    ds_read_b64_tr_b16 v[190:191], v9 offset:27904
    buffer_load_dwordx4 a[56:59], v67, s[44:47], s7 offen offset:2048 sc1
    v_mfma_f32_32x32x16_bf16 v[148:163], a[20:23], v[208:211], v[148:163]
    ds_read_b64_tr_b16 v[192:193], v9 offset:28672
    ds_read_b64_tr_b16 v[194:195], v9 offset:28928
    s_waitcnt vmcnt(8)
    v_mfma_f32_32x32x16_bf16 v[132:147], v[212:215], a[24:27], v[132:147]
    ds_read_b64_tr_b16 v[196:197], v9 offset:29696
    ds_read_b64_tr_b16 v[198:199], v9 offset:29952
    buffer_load_dwordx4 a[60:63], v67, s[44:47], s7 offen offset:3072 sc1
    v_mfma_f32_32x32x16_bf16 v[148:163], a[24:27], v[216:219], v[148:163]
    ds_read_b64_tr_b16 v[200:201], v9 offset:30720
    ds_read_b64_tr_b16 v[202:203], v9 offset:30976
    s_waitcnt vmcnt(8)
    v_mfma_f32_32x32x16_bf16 v[132:147], v[220:223], a[28:31], v[132:147]
    ds_read_b64_tr_b16 v[204:205], v9 offset:31744
    ds_read_b64_tr_b16 v[206:207], v9 offset:32000
    buffer_load_dwordx4 a[64:67], v67, s[44:47], s26 offen offset:0 sc1
    v_mfma_f32_32x32x16_bf16 v[148:163], a[28:31], v[224:227], v[148:163]
    ds_read_b64_tr_b16 v[208:209], v8 offset:1024
    ds_read_b64_tr_b16 v[210:211], v8 offset:1280
    v_mfma_f32_32x32x16_bf16 v[44:59], v[228:231], a[0:3], 0
    ds_read_b64_tr_b16 v[212:213], v9 offset:32768
    ds_read_b64_tr_b16 v[214:215], v9 offset:33024
    s_waitcnt vmcnt(8)
    v_mfma_f32_32x32x16_bf16 v[132:147], v[232:235], a[32:35], v[132:147]
    ds_read_b64_tr_b16 v[216:217], v9 offset:33792
    ds_read_b64_tr_b16 v[218:219], v9 offset:34048
    buffer_load_dwordx4 a[68:71], v67, s[44:47], s26 offen offset:1024 sc1
    v_mfma_f32_32x32x16_bf16 v[148:163], a[32:35], v[236:239], v[148:163]
    ds_read_b64_tr_b16 v[220:221], v9 offset:34816
    ds_read_b64_tr_b16 v[222:223], v9 offset:35072
    s_waitcnt vmcnt(8)
    v_mfma_f32_32x32x16_bf16 v[132:147], v[240:243], a[36:39], v[132:147]
    ds_read_b64_tr_b16 v[224:225], v9 offset:35840
    ds_read_b64_tr_b16 v[226:227], v9 offset:36096
    buffer_load_dwordx4 a[72:75], v67, s[44:47], s26 offen offset:2048 sc1
    v_mfma_f32_32x32x16_bf16 v[148:163], a[36:39], v[244:247], v[148:163]
    ds_read_b64_tr_b16 v[228:229], v9 offset:36864
    ds_read_b64_tr_b16 v[230:231], v9 offset:37120
    s_waitcnt vmcnt(8)
    v_mfma_f32_32x32x16_bf16 v[132:147], v[248:251], a[40:43], v[132:147]
    ds_read_b64_tr_b16 v[232:233], v9 offset:37888
    ds_read_b64_tr_b16 v[234:235], v9 offset:38144
    buffer_load_dwordx4 a[76:79], v67, s[44:47], s26 offen offset:3072 sc1
    v_mfma_f32_32x32x16_bf16 v[148:163], a[40:43], v[164:167], v[148:163]
    ds_read_b64_tr_b16 v[236:237], v9 offset:38912
    ds_read_b64_tr_b16 v[238:239], v9 offset:39168
    s_waitcnt vmcnt(8)
    v_mfma_f32_32x32x16_bf16 v[132:147], v[168:171], a[44:47], v[132:147]
    ds_read_b64_tr_b16 v[240:241], v9 offset:39936
    ds_read_b64_tr_b16 v[242:243], v9 offset:40192
    buffer_load_dwordx4 a[80:83], v67, s[44:47], s27 offen offset:0 sc1
    s_waitcnt lgkmcnt(8)
    v_mfma_f32_32x32x16_bf16 v[148:163], a[44:47], v[172:175], v[148:163]
    ds_read_b64_tr_b16 v[244:245], v9 offset:40960
    ds_read_b64_tr_b16 v[246:247], v9 offset:41216
    s_waitcnt vmcnt(8)
    v_mfma_f32_32x32x16_bf16 v[132:147], v[176:179], a[48:51], v[132:147]
    ds_read_b64_tr_b16 v[248:249], v9 offset:41984
    ds_read_b64_tr_b16 v[250:251], v9 offset:42240
    buffer_load_dwordx4 a[84:87], v67, s[44:47], s27 offen offset:1024 sc1
    v_mfma_f32_32x32x16_bf16 v[148:163], a[48:51], v[180:183], v[148:163]
    ds_read_b64_tr_b16 v[164:165], v9 offset:43008
    ds_read_b64_tr_b16 v[166:167], v9 offset:43264
    s_waitcnt vmcnt(8)
    v_mfma_f32_32x32x16_bf16 v[132:147], v[184:187], a[52:55], v[132:147]
    ds_read_b64_tr_b16 v[168:169], v9 offset:44032
    ds_read_b64_tr_b16 v[170:171], v9 offset:44288
    buffer_load_dwordx4 a[88:91], v67, s[44:47], s27 offen offset:2048 sc1
    v_mfma_f32_32x32x16_bf16 v[148:163], a[52:55], v[188:191], v[148:163]
    ds_read_b64_tr_b16 v[172:173], v9 offset:45056
    ds_read_b64_tr_b16 v[174:175], v9 offset:45312
    s_waitcnt vmcnt(8)
    v_mfma_f32_32x32x16_bf16 v[132:147], v[192:195], a[56:59], v[132:147]
    ds_read_b64_tr_b16 v[176:177], v9 offset:46080
    ds_read_b64_tr_b16 v[178:179], v9 offset:46336
    buffer_load_dwordx4 a[92:95], v67, s[44:47], s27 offen offset:3072 sc1
    v_mfma_f32_32x32x16_bf16 v[148:163], a[56:59], v[196:199], v[148:163]
    ds_read_b64_tr_b16 v[180:181], v9 offset:47104
    ds_read_b64_tr_b16 v[182:183], v9 offset:47360
    s_waitcnt vmcnt(8)
    v_mfma_f32_32x32x16_bf16 v[132:147], v[200:203], a[60:63], v[132:147]
    ds_read_b64_tr_b16 v[184:185], v9 offset:48128
    ds_read_b64_tr_b16 v[186:187], v9 offset:48384
    buffer_load_dwordx4 a[96:99], v67, s[44:47], s30 offen offset:0 sc1
    v_mfma_f32_32x32x16_bf16 v[148:163], a[60:63], v[204:207], v[148:163]
    ds_read_b64_tr_b16 v[188:189], v8 offset:2048
    ds_read_b64_tr_b16 v[190:191], v8 offset:2304
    v_mfma_f32_32x32x16_bf16 v[44:59], v[208:211], a[4:7], v[44:59]
    ds_read_b64_tr_b16 v[192:193], v9 offset:49152
    ds_read_b64_tr_b16 v[194:195], v9 offset:49408
    s_waitcnt vmcnt(8)
    v_mfma_f32_32x32x16_bf16 v[132:147], v[212:215], a[64:67], v[132:147]
    ds_read_b64_tr_b16 v[196:197], v9 offset:50176
    ds_read_b64_tr_b16 v[198:199], v9 offset:50432
    buffer_load_dwordx4 a[100:103], v67, s[44:47], s30 offen offset:1024 sc1
    v_mfma_f32_32x32x16_bf16 v[148:163], a[64:67], v[216:219], v[148:163]
    ds_read_b64_tr_b16 v[200:201], v9 offset:51200
    ds_read_b64_tr_b16 v[202:203], v9 offset:51456
    s_waitcnt vmcnt(8)
    v_mfma_f32_32x32x16_bf16 v[132:147], v[220:223], a[68:71], v[132:147]
    ds_read_b64_tr_b16 v[204:205], v9 offset:52224
    ds_read_b64_tr_b16 v[206:207], v9 offset:52480
    buffer_load_dwordx4 a[104:107], v67, s[44:47], s30 offen offset:2048 sc1
    v_mfma_f32_32x32x16_bf16 v[148:163], a[68:71], v[224:227], v[148:163]
    ds_read_b64_tr_b16 v[208:209], v9 offset:53248
    ds_read_b64_tr_b16 v[210:211], v9 offset:53504
    s_waitcnt vmcnt(8) lgkmcnt(8)
    v_mfma_f32_32x32x16_bf16 v[132:147], v[228:231], a[72:75], v[132:147]
    ds_read_b64_tr_b16 v[212:213], v9 offset:54272
    ds_read_b64_tr_b16 v[214:215], v9 offset:54528
    buffer_load_dwordx4 a[108:111], v67, s[44:47], s30 offen offset:3072 sc1
    v_mfma_f32_32x32x16_bf16 v[148:163], a[72:75], v[232:235], v[148:163]
    ds_read_b64_tr_b16 v[216:217], v9 offset:55296
    ds_read_b64_tr_b16 v[218:219], v9 offset:55552
    s_waitcnt vmcnt(8)
    v_mfma_f32_32x32x16_bf16 v[132:147], v[236:239], a[76:79], v[132:147]
    ds_read_b64_tr_b16 v[220:221], v9 offset:56320
    ds_read_b64_tr_b16 v[222:223], v9 offset:56576
    buffer_load_dwordx4 a[112:115], v67, s[44:47], s31 offen offset:0 sc1
    v_mfma_f32_32x32x16_bf16 v[148:163], a[76:79], v[240:243], v[148:163]
    ds_read_b64_tr_b16 v[224:225], v9 offset:57344
    ds_read_b64_tr_b16 v[226:227], v9 offset:57600
    s_waitcnt vmcnt(8)
    v_mfma_f32_32x32x16_bf16 v[132:147], v[244:247], a[80:83], v[132:147]
    ds_read_b64_tr_b16 v[228:229], v9 offset:58368
    ds_read_b64_tr_b16 v[230:231], v9 offset:58624
    buffer_load_dwordx4 a[116:119], v67, s[44:47], s31 offen offset:1024 sc1
    v_mfma_f32_32x32x16_bf16 v[148:163], a[80:83], v[248:251], v[148:163]
    ds_read_b64_tr_b16 v[232:233], v9 offset:59392
    ds_read_b64_tr_b16 v[234:235], v9 offset:59648
    s_waitcnt vmcnt(8)
    v_mfma_f32_32x32x16_bf16 v[132:147], v[164:167], a[84:87], v[132:147]
    ds_read_b64_tr_b16 v[236:237], v9 offset:60416
    ds_read_b64_tr_b16 v[238:239], v9 offset:60672
    buffer_load_dwordx4 a[120:123], v67, s[44:47], s31 offen offset:2048 sc1
    v_mfma_f32_32x32x16_bf16 v[148:163], a[84:87], v[168:171], v[148:163]
    ds_read_b64_tr_b16 v[240:241], v9 offset:61440
    ds_read_b64_tr_b16 v[242:243], v9 offset:61696
    s_waitcnt vmcnt(8)
    v_mfma_f32_32x32x16_bf16 v[132:147], v[172:175], a[88:91], v[132:147]
    ds_read_b64_tr_b16 v[244:245], v9 offset:62464
    ds_read_b64_tr_b16 v[246:247], v9 offset:62720
    buffer_load_dwordx4 a[124:127], v67, s[44:47], s31 offen offset:3072 sc1
    v_mfma_f32_32x32x16_bf16 v[148:163], a[88:91], v[176:179], v[148:163]
    ds_read_b64_tr_b16 v[248:249], v9 offset:63488
    ds_read_b64_tr_b16 v[250:251], v9 offset:63744
    s_waitcnt vmcnt(8)
    v_mfma_f32_32x32x16_bf16 v[132:147], v[180:183], a[92:95], v[132:147]
    ds_read_b64_tr_b16 v[164:165], v9 offset:64512
    ds_read_b64_tr_b16 v[166:167], v9 offset:64768
    s_add_u32 m0, s5, 4096
    s_mul_i32 s84, s3, 48
    buffer_load_dwordx4 v3, s[12:15], s84 offen lds
    v_mfma_f32_32x32x16_bf16 v[148:163], a[92:95], v[184:187], v[148:163]
    ds_read_b64_tr_b16 v[168:169], v8 offset:3072
    ds_read_b64_tr_b16 v[170:171], v8 offset:3328
    v_mfma_f32_32x32x16_bf16 v[44:59], v[188:191], a[8:11], v[44:59]
    s_waitcnt vmcnt(8)
    v_mfma_f32_32x32x16_bf16 v[132:147], v[192:195], a[96:99], v[132:147]
    s_add_u32 m0, s5, 8192
    s_mul_i32 s84, s6, 48
    buffer_load_dwordx4 v3, s[12:15], s84 offen lds
    s_waitcnt lgkmcnt(8)
    v_mfma_f32_32x32x16_bf16 v[148:163], a[96:99], v[196:199], v[148:163]
    s_waitcnt vmcnt(8)
    v_mfma_f32_32x32x16_bf16 v[132:147], v[200:203], a[100:103], v[132:147]
    s_add_u32 m0, s5, 12288
    s_mul_i32 s84, s7, 48
    buffer_load_dwordx4 v3, s[12:15], s84 offen lds
    v_mfma_f32_32x32x16_bf16 v[148:163], a[100:103], v[204:207], v[148:163]
    s_waitcnt vmcnt(8)
    v_mfma_f32_32x32x16_bf16 v[132:147], v[208:211], a[104:107], v[132:147]
    s_add_u32 m0, s5, 16384
    s_mul_i32 s84, s26, 48
    buffer_load_dwordx4 v3, s[12:15], s84 offen lds
    v_mfma_f32_32x32x16_bf16 v[148:163], a[104:107], v[212:215], v[148:163]
    s_waitcnt vmcnt(8)
    v_mfma_f32_32x32x16_bf16 v[132:147], v[216:219], a[108:111], v[132:147]
    s_add_u32 m0, s5, 20480
    s_mul_i32 s84, s27, 48
    buffer_load_dwordx4 v3, s[12:15], s84 offen lds
    v_mfma_f32_32x32x16_bf16 v[148:163], a[108:111], v[220:223], v[148:163]
    s_waitcnt vmcnt(8)
    v_mfma_f32_32x32x16_bf16 v[132:147], v[224:227], a[112:115], v[132:147]
    s_add_u32 m0, s5, 24576
    s_mul_i32 s84, s30, 48
    buffer_load_dwordx4 v3, s[12:15], s84 offen lds
    v_mfma_f32_32x32x16_bf16 v[148:163], a[112:115], v[228:231], v[148:163]
    s_waitcnt vmcnt(8)
    v_mfma_f32_32x32x16_bf16 v[132:147], v[232:235], a[116:119], v[132:147]
    s_add_u32 m0, s5, 28672
    s_mul_i32 s84, s31, 48
    buffer_load_dwordx4 v3, s[12:15], s84 offen lds
    v_mfma_f32_32x32x16_bf16 v[148:163], a[116:119], v[236:239], v[148:163]
    s_waitcnt vmcnt(8)
    v_mfma_f32_32x32x16_bf16 v[132:147], v[240:243], a[120:123], v[132:147]
    s_waitcnt lgkmcnt(6)
    v_mfma_f32_32x32x16_bf16 v[148:163], a[120:123], v[244:247], v[148:163]
    s_waitcnt vmcnt(7) lgkmcnt(4)
    v_mfma_f32_32x32x16_bf16 v[132:147], v[248:251], a[124:127], v[132:147]
    s_waitcnt lgkmcnt(2)
    v_mfma_f32_32x32x16_bf16 v[148:163], a[124:127], v[164:167], v[148:163]
    s_waitcnt lgkmcnt(0)
    v_mfma_f32_32x32x16_bf16 v[44:59], v[168:171], a[12:15], v[44:59]
    s_nop 7
    v_cvt_pk_bf16_f32 v228, v132, v133
    v_cvt_pk_bf16_f32 v229, v134, v135
    v_cvt_pk_bf16_f32 v230, v136, v137
    v_cvt_pk_bf16_f32 v231, v138, v139
    v_cvt_pk_bf16_f32 v232, v140, v141
    v_cvt_pk_bf16_f32 v233, v142, v143
    v_cvt_pk_bf16_f32 v234, v144, v145
    v_cvt_pk_bf16_f32 v235, v146, v147
    v_mfma_f32_32x32x16_bf16 v[196:211], v[100:103], v[228:231], 0
    s_nop 0
    v_mfma_f32_32x32x16_bf16 v[212:227], v[104:107], v[232:235], 0
    s_mov_b32 exec_lo, 0x0000ffff
    s_mov_b32 exec_hi, 0x0000ffff
    v_cvt_pk_bf16_f32 v116, v148, v149
    v_cvt_pk_bf16_f32 v117, v150, v151
    v_cvt_pk_bf16_f32 v118, v152, v153
    v_cvt_pk_bf16_f32 v119, v154, v155
    v_cvt_pk_bf16_f32 v120, v156, v157
    v_cvt_pk_bf16_f32 v121, v158, v159
    v_cvt_pk_bf16_f32 v122, v160, v161
    v_cvt_pk_bf16_f32 v123, v162, v163
    s_mov_b32 exec_lo, 0xffff0000
    s_mov_b32 exec_hi, 0xffff0000
    v_cvt_pk_bf16_f32 v124, v148, v149
    v_cvt_pk_bf16_f32 v125, v150, v151
    v_cvt_pk_bf16_f32 v126, v152, v153
    v_cvt_pk_bf16_f32 v127, v154, v155
    v_cvt_pk_bf16_f32 v128, v156, v157
    v_cvt_pk_bf16_f32 v129, v158, v159
    v_cvt_pk_bf16_f32 v130, v160, v161
    v_cvt_pk_bf16_f32 v131, v162, v163
    s_mov_b64 exec, -1
    s_barrier
    v_max3_f32 v60, v196, v197, v198
    s_add_u32 m0, s5, 32768
    s_lshl_b32 s84, s73, 4
    buffer_load_dwordx4 v4, s[20:23], s84 offen lds
    v_max3_f32 v68, v212, v213, v214
    v_max3_f32 v61, v199, v200, v201
    v_max3_f32 v69, v215, v216, v217
    v_max3_f32 v60, v60, v202, v203
    v_max3_f32 v68, v68, v218, v219
    v_max3_f32 v61, v61, v204, v205
    v_max3_f32 v69, v69, v220, v221
    v_max3_f32 v60, v60, v206, v207
    s_add_u32 m0, s5, 36864
    s_nop 0
    buffer_load_dwordx4 v27, s[20:23], s84 offen lds
    v_max3_f32 v68, v68, v222, v223
    v_max3_f32 v61, v61, v208, v209
    v_max3_f32 v69, v69, v224, v225
    v_max3_f32 v60, v60, v210, v211
    v_max3_f32 v68, v68, v226, v227
    v_max_f32 v60, v60, v61
    v_max_f32 v68, v68, v69
    v_mul_f32 v60, 0xbfb8aa3b, v60
    v_mul_f32 v68, 0xbfb8aa3b, v68
    s_add_u32 m0, s5, 40960
    s_lshl_b32 s84, s3, 4
    buffer_load_dwordx4 v4, s[20:23], s84 offen lds
    v_pk_fma_f32 v[196:197], v[196:197], s[70:71], v[60:61] op_sel_hi:[1,0,0]
    v_pk_fma_f32 v[212:213], v[212:213], s[70:71], v[68:69] op_sel_hi:[1,0,0]
    v_pk_fma_f32 v[198:199], v[198:199], s[70:71], v[60:61] op_sel_hi:[1,0,0]
    v_pk_fma_f32 v[214:215], v[214:215], s[70:71], v[68:69] op_sel_hi:[1,0,0]
    v_pk_fma_f32 v[200:201], v[200:201], s[70:71], v[60:61] op_sel_hi:[1,0,0]
    v_pk_fma_f32 v[216:217], v[216:217], s[70:71], v[68:69] op_sel_hi:[1,0,0]
    v_pk_fma_f32 v[202:203], v[202:203], s[70:71], v[60:61] op_sel_hi:[1,0,0]
    v_pk_fma_f32 v[218:219], v[218:219], s[70:71], v[68:69] op_sel_hi:[1,0,0]
    v_pk_fma_f32 v[204:205], v[204:205], s[70:71], v[60:61] op_sel_hi:[1,0,0]
    s_add_u32 m0, s5, 45056
    s_nop 0
    buffer_load_dwordx4 v27, s[20:23], s84 offen lds
    v_pk_fma_f32 v[220:221], v[220:221], s[70:71], v[68:69] op_sel_hi:[1,0,0]
    v_pk_fma_f32 v[206:207], v[206:207], s[70:71], v[60:61] op_sel_hi:[1,0,0]
    v_pk_fma_f32 v[222:223], v[222:223], s[70:71], v[68:69] op_sel_hi:[1,0,0]
    v_pk_fma_f32 v[208:209], v[208:209], s[70:71], v[60:61] op_sel_hi:[1,0,0]
    v_pk_fma_f32 v[224:225], v[224:225], s[70:71], v[68:69] op_sel_hi:[1,0,0]
    v_pk_fma_f32 v[210:211], v[210:211], s[70:71], v[60:61] op_sel_hi:[1,0,0]
    v_pk_fma_f32 v[226:227], v[226:227], s[70:71], v[68:69] op_sel_hi:[1,0,0]
    v_exp_f32 v196, v196
    s_add_u32 m0, s5, 49152
    s_lshl_b32 s84, s6, 4
    buffer_load_dwordx4 v4, s[20:23], s84 offen lds
    v_exp_f32 v212, v212
    v_exp_f32 v197, v197
    v_exp_f32 v213, v213
    v_exp_f32 v198, v198
    v_exp_f32 v214, v214
    v_exp_f32 v199, v199
    v_exp_f32 v215, v215
    v_exp_f32 v200, v200
    v_exp_f32 v216, v216
    s_add_u32 m0, s5, 53248
    s_nop 0
    buffer_load_dwordx4 v27, s[20:23], s84 offen lds
    v_exp_f32 v201, v201
    v_exp_f32 v217, v217
    v_exp_f32 v202, v202
    v_exp_f32 v218, v218
    v_exp_f32 v203, v203
    v_exp_f32 v219, v219
    v_exp_f32 v204, v204
    v_exp_f32 v220, v220
    v_exp_f32 v205, v205
    s_add_u32 m0, s5, 57344
    s_lshl_b32 s84, s7, 4
    buffer_load_dwordx4 v4, s[20:23], s84 offen lds
    v_exp_f32 v221, v221
    v_exp_f32 v206, v206
    v_exp_f32 v222, v222
    v_exp_f32 v207, v207
    v_exp_f32 v223, v223
L_page_2:
    s_cbranch_execz L_page_4
    v_exp_f32 v208, v208
    v_exp_f32 v224, v224
    v_exp_f32 v209, v209
    s_add_u32 m0, s5, 61440
    s_nop 0
    buffer_load_dwordx4 v27, s[20:23], s84 offen lds
    v_exp_f32 v225, v225
    v_exp_f32 v210, v210
    v_exp_f32 v226, v226
    v_exp_f32 v211, v211
    v_exp_f32 v227, v227
    v_pk_add_f32 v[60:61], v[196:197], v[198:199]
    v_pk_add_f32 v[68:69], v[212:213], v[214:215]
    v_pk_add_f32 v[62:63], v[200:201], v[202:203]
    v_pk_add_f32 v[70:71], v[216:217], v[218:219]
    s_add_u32 m0, s5, 65536
    s_lshl_b32 s84, s26, 4
    buffer_load_dwordx4 v4, s[20:23], s84 offen lds
    v_pk_add_f32 v[60:61], v[60:61], v[204:205]
    v_pk_add_f32 v[68:69], v[68:69], v[220:221]
    v_pk_add_f32 v[62:63], v[62:63], v[206:207]
    v_pk_add_f32 v[70:71], v[70:71], v[222:223]
    v_pk_add_f32 v[60:61], v[60:61], v[208:209]
    v_pk_add_f32 v[68:69], v[68:69], v[224:225]
    v_pk_add_f32 v[62:63], v[62:63], v[210:211]
    v_pk_add_f32 v[70:71], v[70:71], v[226:227]
    v_pk_add_f32 v[60:61], v[60:61], v[62:63]
    s_add_u32 m0, s5, 69632
    s_nop 0
    buffer_load_dwordx4 v27, s[20:23], s84 offen lds
    v_pk_add_f32 v[68:69], v[68:69], v[70:71]
    v_add_f32 v60, v60, v61
    v_add_f32 v68, v68, v69
    v_rcp_f32 v60, v60
    v_rcp_f32 v68, v68
    v_pk_mul_f32 v[196:197], v[196:197], v[60:61] op_sel_hi:[1,0]
    v_pk_mul_f32 v[212:213], v[212:213], v[68:69] op_sel_hi:[1,0]
    v_pk_mul_f32 v[198:199], v[198:199], v[60:61] op_sel_hi:[1,0]
    buffer_load_dword v255, v253, s[16:19], s25 offen sc1
    v_pk_mul_f32 v[214:215], v[214:215], v[68:69] op_sel_hi:[1,0]
    v_pk_mul_f32 v[200:201], v[200:201], v[60:61] op_sel_hi:[1,0]
    v_pk_mul_f32 v[216:217], v[216:217], v[68:69] op_sel_hi:[1,0]
    v_pk_mul_f32 v[202:203], v[202:203], v[60:61] op_sel_hi:[1,0]
    v_pk_mul_f32 v[218:219], v[218:219], v[68:69] op_sel_hi:[1,0]
    v_pk_mul_f32 v[204:205], v[204:205], v[60:61] op_sel_hi:[1,0]
    v_pk_mul_f32 v[220:221], v[220:221], v[68:69] op_sel_hi:[1,0]
    v_pk_mul_f32 v[206:207], v[206:207], v[60:61] op_sel_hi:[1,0]
    v_pk_mul_f32 v[222:223], v[222:223], v[68:69] op_sel_hi:[1,0]
    s_add_u32 m0, s5, 73728
    s_lshl_b32 s84, s27, 4
    buffer_load_dwordx4 v4, s[20:23], s84 offen lds
    v_pk_mul_f32 v[208:209], v[208:209], v[60:61] op_sel_hi:[1,0]
    v_pk_mul_f32 v[224:225], v[224:225], v[68:69] op_sel_hi:[1,0]
    v_pk_mul_f32 v[210:211], v[210:211], v[60:61] op_sel_hi:[1,0]
    v_pk_mul_f32 v[226:227], v[226:227], v[68:69] op_sel_hi:[1,0]
    v_cvt_pk_bf16_f32 v236, v196, v197
    v_cvt_pk_bf16_f32 v244, v212, v213
    v_cvt_pk_bf16_f32 v237, v198, v199
    v_cvt_pk_bf16_f32 v245, v214, v215
    v_cvt_pk_bf16_f32 v238, v200, v201
    s_add_u32 m0, s5, 77824
    s_nop 0
    buffer_load_dwordx4 v27, s[20:23], s84 offen lds
    v_cvt_pk_bf16_f32 v246, v216, v217
    v_cvt_pk_bf16_f32 v239, v202, v203
    v_cvt_pk_bf16_f32 v247, v218, v219
    v_cvt_pk_bf16_f32 v240, v204, v205
    v_cvt_pk_bf16_f32 v248, v220, v221
    v_cvt_pk_bf16_f32 v241, v206, v207
    v_cvt_pk_bf16_f32 v249, v222, v223
    v_cvt_pk_bf16_f32 v242, v208, v209
    s_add_u32 m0, s5, 81920
    s_lshl_b32 s84, s30, 4
    buffer_load_dwordx4 v4, s[20:23], s84 offen lds
    v_cvt_pk_bf16_f32 v250, v224, v225
    v_cvt_pk_bf16_f32 v243, v210, v211
    v_cvt_pk_bf16_f32 v251, v226, v227
    v_mfma_f32_32x32x16_bf16 v[196:211], v[236:239], v[108:111], 0
    v_mfma_f32_32x32x16_bf16 v[212:227], v[244:247], v[108:111], 0
    v_mfma_f32_32x32x16_bf16 v[196:211], v[240:243], v[112:115], v[196:211]
    v_mfma_f32_32x32x16_bf16 v[212:227], v[248:251], v[112:115], v[212:227]
    s_nop 10
    v_cvt_pk_bf16_f32 v236, v196, v197
    v_cvt_pk_bf16_f32 v237, v198, v199
    s_add_u32 m0, s5, 86016
    s_nop 0
    buffer_load_dwordx4 v27, s[20:23], s84 offen lds
    v_cvt_pk_bf16_f32 v238, v200, v201
    v_cvt_pk_bf16_f32 v239, v202, v203
    v_cvt_pk_bf16_f32 v240, v204, v205
    v_cvt_pk_bf16_f32 v241, v206, v207
    v_cvt_pk_bf16_f32 v242, v208, v209
    v_cvt_pk_bf16_f32 v243, v210, v211
    v_mfma_f32_32x32x16_bf16 v[132:147], v[236:239], v[116:119], 0
    s_nop 0
    v_mfma_f32_32x32x16_bf16 v[132:147], v[240:243], v[120:123], v[132:147]
    v_cvt_pk_bf16_f32 v244, v212, v213
    s_add_u32 m0, s5, 90112
    s_lshl_b32 s84, s31, 4
    buffer_load_dwordx4 v4, s[20:23], s84 offen lds
    v_cvt_pk_bf16_f32 v245, v214, v215
    v_cvt_pk_bf16_f32 v246, v216, v217
    v_cvt_pk_bf16_f32 v247, v218, v219
    v_cvt_pk_bf16_f32 v248, v220, v221
    v_cvt_pk_bf16_f32 v249, v222, v223
    v_cvt_pk_bf16_f32 v250, v224, v225
    v_cvt_pk_bf16_f32 v251, v226, v227
    v_mfma_f32_32x32x16_bf16 v[132:147], v[244:247], v[124:127], v[132:147]
    s_add_u32 m0, s5, 94208
    s_nop 0
    buffer_load_dwordx4 v27, s[20:23], s84 offen lds
    v_mfma_f32_32x32x16_bf16 v[132:147], v[248:251], v[128:131], v[132:147]
    v_pk_add_f32 v[196:197], v[196:197], v[204:205]
    v_pk_add_f32 v[212:213], v[212:213], v[220:221]
    v_pk_add_f32 v[198:199], v[198:199], v[206:207]
    v_pk_add_f32 v[214:215], v[214:215], v[222:223]
    v_pk_add_f32 v[200:201], v[200:201], v[208:209]
    v_pk_add_f32 v[216:217], v[216:217], v[224:225]
    v_pk_add_f32 v[202:203], v[202:203], v[210:211]
    v_pk_add_f32 v[218:219], v[218:219], v[226:227]
    s_mov_b32 s25, 393216
    v_lshrrev_b32 v253, 3, v253
    buffer_load_dword v255, v253, s[16:19], s25 offen sc1
    v_pk_add_f32 v[196:197], v[196:197], v[200:201]
    v_pk_add_f32 v[212:213], v[212:213], v[216:217]
    v_pk_add_f32 v[198:199], v[198:199], v[202:203]
    v_pk_add_f32 v[214:215], v[214:215], v[218:219]
    v_pk_add_f32 v[196:197], v[196:197], v[198:199]
    v_pk_add_f32 v[212:213], v[212:213], v[214:215]
    v_add_f32 v64, v196, v197
    v_add_f32 v65, v212, v213
    s_nop 1
    v_permlane32_swap_b32 v64, v65
    v_add_f32 v64, v64, v65
    ds_write_b32 v86, v64
    ds_write_b128 v87, v[132:135] offset:0
    ds_write_b128 v87, v[136:139] offset:1024
    ds_write_b128 v87, v[140:143] offset:2048
    ds_write_b128 v87, v[144:147] offset:3072
    s_lshl_b32 s63, s76, 14
    s_xor_b32 s40, s73, s63
    s_xor_b32 s41, s3, s63
    s_xor_b32 s42, s6, s63
    s_xor_b32 s43, s7, s63
    s_lshl_b32 s73, s82, 12
    s_add_u32 s3, s73, 4096
    s_and_b32 s3, s3, 0x7fff
    s_add_u32 s6, s3, 4096
    s_and_b32 s6, s6, 0x7fff
    s_add_u32 s7, s6, 4096
    s_and_b32 s7, s7, 0x7fff
    s_add_u32 s26, s7, 4096
    s_and_b32 s26, s26, 0x7fff
    s_add_u32 s27, s26, 4096
    s_and_b32 s27, s27, 0x7fff
    s_add_u32 s30, s27, 4096
    s_and_b32 s30, s30, 0x7fff
    s_add_u32 s31, s30, 4096
    s_and_b32 s31, s31, 0x7fff
    s_waitcnt vmcnt(18)
    s_waitcnt lgkmcnt(0)
    s_barrier
    ds_read_b128 v[196:199], v88 offset:0
    ds_read_b128 v[200:203], v88 offset:4096
    ds_read_b128 v[204:207], v88 offset:8192
    ds_read_b128 v[208:211], v88 offset:12288
    ds_read_b128 v[212:215], v89
    ds_read_b64_tr_b16 v[164:165], v8 offset:4096
    ds_read_b64_tr_b16 v[166:167], v8 offset:4352
    ds_read_b64_tr_b16 v[168:169], v8 offset:5120
    ds_read_b64_tr_b16 v[170:171], v8 offset:5376
    ds_read_b64_tr_b16 v[172:173], v8 offset:6144
    ds_read_b64_tr_b16 v[174:175], v8 offset:6400
    ds_read_b64_tr_b16 v[176:177], v8 offset:7168
    ds_read_b64_tr_b16 v[178:179], v8 offset:7424
    ds_read_b64_tr_b16 v[180:181], v8 offset:8192
    ds_read_b64_tr_b16 v[182:183], v8 offset:8448
    v_bfe_u32 v60, v91, 1, 4
    s_mov_b32 s63, 0x00010001
    v_lshrrev_b32 v60, v60, s72
    s_mov_b32 s64, 0x07060302
    v_lshrrev_b32 v61, 1, v60
    v_and_b32 v62, 24, v90
    s_movk_i32 s65, 0xff
    v_lshrrev_b32 v62, v62, s72
    s_waitcnt lgkmcnt(13)
    v_pk_add_f32 v[196:197], v[196:197], v[200:201]
    v_pk_add_f32 v[198:199], v[198:199], v[202:203]
    s_waitcnt lgkmcnt(11)
    v_pk_add_f32 v[204:205], v[204:205], v[208:209]
    v_pk_add_f32 v[206:207], v[206:207], v[210:211]
    v_pk_add_f32 v[196:197], v[196:197], v[204:205]
    v_pk_add_f32 v[198:199], v[198:199], v[206:207]
    v_perm_b32 v200, v197, v196, s64
    v_perm_b32 v201, v199, v198, s64
    v_add_u32 v200, s63, v200
    v_add_u32 v201, s63, v201
    v_bfi_b32 v200, s63, v60, v200
    v_bfi_b32 v201, s63, v61, v201
    buffer_store_dwordx2 v[200:201], v90, s[52:55], s80 offen sc1
    s_cmp_lg_u32 s62, 3
    s_cbranch_scc1 L_noz_22
    s_waitcnt lgkmcnt(10)
    v_pk_add_f32 v[212:213], v[212:213], v[214:215]
    v_add_f32 v212, v212, v213
    v_add_u32 v212, 0x80, v212
    v_bfi_b32 v212, s65, v62, v212
    buffer_store_dword v212, v91, s[52:55], s79 offen offset:2048 sc1
L_noz_22:
    s_waitcnt lgkmcnt(8)
    v_mfma_f32_32x32x16_bf16 v[44:59], v[164:167], a[16:19], v[44:59]
    ds_read_b64_tr_b16 v[184:185], v8 offset:9216
    ds_read_b64_tr_b16 v[186:187], v8 offset:9472
    s_add_u32 m0, s4, 98304
    s_mul_i32 s84, s30, 43
    s_add_u32 s84, s84, 88064
    buffer_load_dwordx4 v5, s[56:59], s84 offen offset:0 lds
    s_waitcnt lgkmcnt(8)
    v_mfma_f32_32x32x16_bf16 v[44:59], v[168:171], a[20:23], v[44:59]
    ds_read_b64_tr_b16 v[188:189], v8 offset:10240
    ds_read_b64_tr_b16 v[190:191], v8 offset:10496
    buffer_load_dwordx4 v6, s[56:59], s84 offen offset:1024 lds
    s_lshl2_add_u32 s63, s60, s77
    s_waitcnt lgkmcnt(8)
    v_mfma_f32_32x32x16_bf16 v[44:59], v[172:175], a[24:27], v[44:59]
    ds_read_b64_tr_b16 v[192:193], v8 offset:11264
    ds_read_b64_tr_b16 v[194:195], v8 offset:11520
    buffer_load_dwordx4 v7, s[56:59], s84 offen offset:2048 lds
    s_lshl_b32 s63, s63, 15
    s_waitcnt lgkmcnt(8)
    v_mfma_f32_32x32x16_bf16 v[44:59], v[176:179], a[28:31], v[44:59]
    ds_read_b64_tr_b16 v[164:165], v8 offset:12288
    ds_read_b64_tr_b16 v[166:167], v8 offset:12544
    s_add_u32 m0, s4, 110592
    s_mul_i32 s84, s31, 43
    buffer_load_dwordx4 v5, s[56:59], s84 offen offset:0 lds
    s_waitcnt lgkmcnt(8)
    v_mfma_f32_32x32x16_bf16 v[44:59], v[180:183], a[32:35], v[44:59]
    ds_read_b64_tr_b16 v[168:169], v8 offset:13312
    ds_read_b64_tr_b16 v[170:171], v8 offset:13568
    buffer_load_dwordx4 v6, s[56:59], s84 offen offset:1024 lds
    s_lshl1_add_u32 s64, s78, s76
    s_lshl_b32 s64, s64, 6
    s_waitcnt lgkmcnt(8)
    v_mfma_f32_32x32x16_bf16 v[44:59], v[184:187], a[36:39], v[44:59]
    ds_read_b64_tr_b16 v[172:173], v8 offset:14336
    ds_read_b64_tr_b16 v[174:175], v8 offset:14592
    s_add_u32 s36, s63, s64
    v_lshrrev_b32 v68, 5, v1
    v_and_b32 v69, 31, v1
    s_waitcnt lgkmcnt(8)
    v_mfma_f32_32x32x16_bf16 v[44:59], v[188:191], a[40:43], v[44:59]
    ds_read_b64_tr_b16 v[176:177], v8 offset:15360
    ds_read_b64_tr_b16 v[178:179], v8 offset:15616
    buffer_load_dwordx4 v7, s[56:59], s84 offen offset:2048 lds
    v_lshlrev_b32 v20, 10, v69
    v_lshl_add_u32 v20, v68, 4, v20
    s_waitcnt lgkmcnt(8)
    v_mfma_f32_32x32x16_bf16 v[44:59], v[192:195], a[44:47], v[44:59]
    ds_read_b64_tr_b16 v[180:181], v8 offset:16384
    ds_read_b64_tr_b16 v[182:183], v8 offset:16640
    s_lshl_b32 s63, s76, 6
    v_xor_b32 v10, s63, v10
    v_xor_b32 v11, s63, v11
    s_waitcnt lgkmcnt(8)
    v_mfma_f32_32x32x16_bf16 v[44:59], v[164:167], a[48:51], v[44:59]
    ds_read_b64_tr_b16 v[184:185], v8 offset:17408
    ds_read_b64_tr_b16 v[186:187], v8 offset:17664
    s_lshl_b32 s63, s76, 15
    v_add_u32 v66, s63, v10
    s_waitcnt lgkmcnt(8)
    v_mfma_f32_32x32x16_bf16 v[44:59], v[168:171], a[52:55], v[44:59]
    ds_read_b64_tr_b16 v[188:189], v8 offset:18432
    ds_read_b64_tr_b16 v[190:191], v8 offset:18688
    v_add_u32 v67, s63, v11
    s_mul_i32 s65, s61, 36864
    s_add_u32 s65, s65, 262144
    s_waitcnt lgkmcnt(8)
    v_mfma_f32_32x32x16_bf16 v[44:59], v[172:175], a[56:59], v[44:59]
    ds_read_b64_tr_b16 v[192:193], v8 offset:19456
    ds_read_b64_tr_b16 v[194:195], v8 offset:19712
    s_lshl_b32 s63, s62, 6
    s_add_u32 s64, s65, s63
    s_lshl3_add_u32 s65, s63, s65
    s_waitcnt lgkmcnt(8)
    v_mfma_f32_32x32x16_bf16 v[44:59], v[176:179], a[60:63], v[44:59]
    ds_read_b64_tr_b16 v[164:165], v8 offset:20480
    ds_read_b64_tr_b16 v[166:167], v8 offset:20736
    v_lshrrev_b32 v71, 4, v1
    v_and_b32 v73, 0xf0, v2
    v_mul_u32_u24 v70, 2304, v71
    s_waitcnt lgkmcnt(8)
    v_mfma_f32_32x32x16_bf16 v[44:59], v[180:183], a[64:67], v[44:59]
    ds_read_b64_tr_b16 v[168:169], v8 offset:21504
    ds_read_b64_tr_b16 v[170:171], v8 offset:21760
    v_and_b32 v71, 1, v71
    v_add_u32 v70, v70, v73
    v_lshl_add_u32 v73, v71, 3, v73
    s_waitcnt lgkmcnt(8)
    v_mfma_f32_32x32x16_bf16 v[44:59], v[184:187], a[68:71], v[44:59]
    ds_read_b64_tr_b16 v[172:173], v8 offset:22528
    ds_read_b64_tr_b16 v[174:175], v8 offset:22784
    v_lshrrev_b32 v71, 2, v1
    v_mul_u32_u24 v71, 2304, v71
    v_and_b32 v72, 3, v1
    s_waitcnt lgkmcnt(8)
    v_mfma_f32_32x32x16_bf16 v[44:59], v[188:191], a[72:75], v[44:59]
    ds_read_b64_tr_b16 v[176:177], v8 offset:23552
    ds_read_b64_tr_b16 v[178:179], v8 offset:23808
    v_lshl_add_u32 v71, v72, 4, v71
    v_add_u32 v71, s64, v71
    s_waitcnt lgkmcnt(8)
    v_mfma_f32_32x32x16_bf16 v[44:59], v[192:195], a[76:79], v[44:59]
    ds_read_b64_tr_b16 v[180:181], v8 offset:24576
    ds_read_b64_tr_b16 v[182:183], v8 offset:24832
    v_lshlrev_b32 v77, 3, v72
    v_bfe_u32 v77, s72, v77, 8
    v_lshlrev_b32 v81, 2, v72
    s_waitcnt lgkmcnt(8)
    v_mfma_f32_32x32x16_bf16 v[44:59], v[164:167], a[80:83], v[44:59]
    ds_read_b64_tr_b16 v[184:185], v8 offset:25600
    ds_read_b64_tr_b16 v[186:187], v8 offset:25856
    v_lshrrev_b32 v81, v81, s72
    v_lshrrev_b32 v82, 1, v81
    v_lshrrev_b32 v83, 2, v81
    s_waitcnt lgkmcnt(8)
    v_mfma_f32_32x32x16_bf16 v[44:59], v[168:171], a[84:87], v[44:59]
    ds_read_b64_tr_b16 v[188:189], v8 offset:26624
    ds_read_b64_tr_b16 v[190:191], v8 offset:26880
    v_lshrrev_b32 v84, 3, v81
    s_mov_b32 s63, 0x00010001
    v_and_b32 v81, s63, v81
    s_waitcnt lgkmcnt(8)
    v_mfma_f32_32x32x16_bf16 v[44:59], v[172:175], a[88:91], v[44:59]
    ds_read_b64_tr_b16 v[192:193], v8 offset:27648
    ds_read_b64_tr_b16 v[194:195], v8 offset:27904
    v_and_b32 v82, s63, v82
    v_and_b32 v83, s63, v83
    v_and_b32 v84, s63, v84
    s_waitcnt lgkmcnt(8)
    v_mfma_f32_32x32x16_bf16 v[44:59], v[176:179], a[92:95], v[44:59]
    ds_read_b64_tr_b16 v[164:165], v8 offset:28672
    ds_read_b64_tr_b16 v[166:167], v8 offset:28928
    s_mul_i32 s63, s62, 544
    s_add_u32 s63, s63, 137216
    s_waitcnt lgkmcnt(8)
    v_mfma_f32_32x32x16_bf16 v[44:59], v[180:183], a[96:99], v[44:59]
    ds_read_b64_tr_b16 v[168:169], v8 offset:29696
    ds_read_b64_tr_b16 v[170:171], v8 offset:29952
    v_lshl_add_u32 v73, v68, 8, v73
    v_add_u32 v73, s63, v73
    s_and_b32 s63, s62, 1
    s_waitcnt lgkmcnt(8)
    v_mfma_f32_32x32x16_bf16 v[44:59], v[184:187], a[100:103], v[44:59]
    ds_read_b64_tr_b16 v[172:173], v8 offset:30720
    ds_read_b64_tr_b16 v[174:175], v8 offset:30976
    s_mul_i32 s63, s63, 1088
    s_lshl4_add_u32 s63, s76, s63
    s_add_u32 s63, s63, 137728
    s_waitcnt lgkmcnt(8)
    v_mfma_f32_32x32x16_bf16 v[44:59], v[188:191], a[104:107], v[44:59]
    ds_read_b64_tr_b16 v[176:177], v8 offset:31744
    ds_read_b64_tr_b16 v[178:179], v8 offset:32000
    v_lshrrev_b32 v74, 1, v72
    v_mul_u32_u24 v74, 544, v74
    v_and_b32 v72, 1, v72
    s_waitcnt lgkmcnt(8)
    v_mfma_f32_32x32x16_bf16 v[44:59], v[192:195], a[108:111], v[44:59]
    v_lshl_add_u32 v74, v72, 3, v74
    v_lshrrev_b32 v72, 4, v1
    v_lshl_add_u32 v74, v72, 1, v74
    v_add_u32 v74, s63, v74
    v_add_u32 v72, 137216, v90
    s_waitcnt lgkmcnt(6)
    v_mfma_f32_32x32x16_bf16 v[44:59], v[164:167], a[112:115], v[44:59]
    v_lshlrev_b32 v76, 3, v68
    v_add_u32 v75, 137728, v76
    v_add_u32 v76, 137744, v76
    v_cmp_gt_u32 vcc, 16, v69
    s_lshl_b32 s63, s78, 8
    s_waitcnt lgkmcnt(4)
    v_mfma_f32_32x32x16_bf16 v[44:59], v[168:171], a[116:119], v[44:59]
    s_lshl1_add_u32 s63, s5, s63
    v_cndmask_b32 v75, v75, v72, vcc
    v_cndmask_b32 v76, v72, v76, vcc
    s_add_u32 s63, s63, 69632
    s_waitcnt lgkmcnt(2)
    v_mfma_f32_32x32x16_bf16 v[44:59], v[172:175], a[120:123], v[44:59]
    v_add_u32 v69, s63, v91
    s_add_u32 s63, s5, 71680
    v_add_u32 v68, s63, v2
    s_mul_i32 s63, s62, 16
    s_add_u32 s63, s63, s61
    s_waitcnt lgkmcnt(0)
    v_mfma_f32_32x32x16_bf16 v[44:59], v[176:179], a[124:127], v[44:59]
    s_lshl_b32 s63, s63, 11
    s_add_u32 s82, s63, 131072
    s_movk_i32 s79, 12288
    s_movk_i32 s80, 24576
    s_mov_b32 s81, 36864
    s_waitcnt vmcnt(8)
    s_barrier
    s_nop 4
    v_cvt_pk_bf16_f32 v228, v44, v45
    v_cvt_pk_bf16_f32 v229, v46, v47
    v_cvt_pk_bf16_f32 v230, v48, v49
    v_cvt_pk_bf16_f32 v231, v50, v51
    v_cvt_pk_bf16_f32 v232, v52, v53
    v_cvt_pk_bf16_f32 v233, v54, v55
    v_cvt_pk_bf16_f32 v234, v56, v57
    v_cvt_pk_bf16_f32 v235, v58, v59
    v_mfma_f32_32x32x16_bf16 v[196:211], v[100:103], v[228:231], 0
    s_nop 0
    v_mfma_f32_32x32x16_bf16 v[212:227], v[104:107], v[232:235], 0
    ds_read_b64_tr_b16 a[0:1], v66 offset:32768
    ds_read_b64_tr_b16 a[2:3], v66 offset:33792
    ds_read_b64_tr_b16 a[4:5], v67 offset:32768
    ds_read_b64_tr_b16 a[6:7], v67 offset:33792
    ds_read_b64_tr_b16 a[8:9], v66 offset:34816
    ds_read_b64_tr_b16 a[10:11], v66 offset:35840
    ds_read_b64_tr_b16 a[12:13], v67 offset:34816
    ds_read_b64_tr_b16 a[14:15], v67 offset:35840
    ds_read_b64_tr_b16 a[16:17], v66 offset:36864
    ds_read_b64_tr_b16 a[18:19], v66 offset:37888
    ds_read_b64_tr_b16 a[20:21], v67 offset:36864
    ds_read_b64_tr_b16 a[22:23], v67 offset:37888
    v_max3_f32 v60, v196, v197, v198
    ds_read_b64_tr_b16 a[24:25], v66 offset:38912
    v_max3_f32 v61, v199, v200, v201
    v_max3_f32 v60, v60, v202, v203
    ds_read_b64_tr_b16 a[26:27], v66 offset:39936
    v_max3_f32 v61, v61, v204, v205
    v_max3_f32 v60, v60, v206, v207
    v_max3_f32 v61, v61, v208, v209
    ds_read_b64_tr_b16 a[28:29], v67 offset:38912
    v_max3_f32 v60, v60, v210, v211
    v_max_f32 v60, v60, v61
    v_mul_f32 v60, 0xbfb8aa3b, v60
    ds_read_b64_tr_b16 a[30:31], v67 offset:39936
    buffer_load_dwordx4 v[164:167], v70, s[52:55], s65 offen offset:0 sc1
    buffer_load_dwordx4 v[168:171], v70, s[52:55], s65 offen offset:256 sc1
    s_add_u32 s65, s65, 9216
    buffer_load_dwordx4 v[172:175], v70, s[52:55], s65 offen offset:0 sc1
    buffer_load_dwordx4 v[176:179], v70, s[52:55], s65 offen offset:256 sc1
    s_add_u32 s65, s65, 9216
    buffer_load_dwordx4 v[180:183], v70, s[52:55], s65 offen offset:0 sc1
    buffer_load_dwordx4 v[184:187], v70, s[52:55], s65 offen offset:256 sc1
    s_add_u32 s65, s65, 9216
    buffer_load_dwordx4 v[188:191], v70, s[52:55], s65 offen offset:0 sc1
    buffer_load_dwordx4 v[192:195], v70, s[52:55], s65 offen offset:256 sc1
    buffer_load_dwordx4 v[136:139], v71, s[52:55], 0 offen offset:2048 sc1
    v_pk_fma_f32 v[196:197], v[196:197], s[70:71], v[60:61] op_sel_hi:[1,0,0]
    v_pk_fma_f32 v[198:199], v[198:199], s[70:71], v[60:61] op_sel_hi:[1,0,0]
    v_pk_fma_f32 v[200:201], v[200:201], s[70:71], v[60:61] op_sel_hi:[1,0,0]
    ds_read_b64_tr_b16 a[32:33], v66 offset:40960
    v_pk_fma_f32 v[202:203], v[202:203], s[70:71], v[60:61] op_sel_hi:[1,0,0]
    v_pk_fma_f32 v[204:205], v[204:205], s[70:71], v[60:61] op_sel_hi:[1,0,0]
    v_pk_fma_f32 v[206:207], v[206:207], s[70:71], v[60:61] op_sel_hi:[1,0,0]
    ds_read_b64_tr_b16 a[34:35], v66 offset:41984
    v_pk_fma_f32 v[208:209], v[208:209], s[70:71], v[60:61] op_sel_hi:[1,0,0]
    v_pk_fma_f32 v[210:211], v[210:211], s[70:71], v[60:61] op_sel_hi:[1,0,0]
    v_exp_f32 v196, v196
    ds_read_b64_tr_b16 a[36:37], v67 offset:40960
    v_exp_f32 v197, v197
    v_exp_f32 v198, v198
    v_exp_f32 v199, v199
    ds_read_b64_tr_b16 a[38:39], v67 offset:41984
    v_exp_f32 v200, v200
    v_exp_f32 v201, v201
    v_exp_f32 v202, v202
    ds_read_b64_tr_b16 a[40:41], v66 offset:43008
    v_exp_f32 v203, v203
    v_exp_f32 v204, v204
    v_exp_f32 v205, v205
    ds_read_b64_tr_b16 a[42:43], v66 offset:44032
    v_exp_f32 v206, v206
    v_exp_f32 v207, v207
    v_exp_f32 v208, v208
    ds_read_b64_tr_b16 a[44:45], v67 offset:43008
    v_exp_f32 v209, v209
    v_exp_f32 v210, v210
    ds_read_b64_tr_b16 a[46:47], v67 offset:44032
    v_exp_f32 v211, v211
    v_pk_add_f32 v[60:61], v[196:197], v[198:199]
    v_pk_add_f32 v[62:63], v[200:201], v[202:203]
    ds_read_b64_tr_b16 a[48:49], v66 offset:45056
    v_pk_add_f32 v[60:61], v[60:61], v[204:205]
    v_pk_add_f32 v[62:63], v[62:63], v[206:207]
    v_pk_add_f32 v[60:61], v[60:61], v[208:209]
    ds_read_b64_tr_b16 a[50:51], v66 offset:46080
    v_pk_add_f32 v[62:63], v[62:63], v[210:211]
    v_pk_add_f32 v[60:61], v[60:61], v[62:63]
    v_add_f32 v60, v60, v61
    ds_read_b64_tr_b16 a[52:53], v67 offset:45056
    v_rcp_f32 v60, v60
    s_nop 0
    v_pk_mul_f32 v[196:197], v[196:197], v[60:61] op_sel_hi:[1,0]
    v_pk_mul_f32 v[198:199], v[198:199], v[60:61] op_sel_hi:[1,0]
    ds_read_b64_tr_b16 a[54:55], v67 offset:46080
    v_pk_mul_f32 v[200:201], v[200:201], v[60:61] op_sel_hi:[1,0]
    v_pk_mul_f32 v[202:203], v[202:203], v[60:61] op_sel_hi:[1,0]
    v_pk_mul_f32 v[204:205], v[204:205], v[60:61] op_sel_hi:[1,0]
    ds_read_b64_tr_b16 a[56:57], v66 offset:47104
    v_pk_mul_f32 v[206:207], v[206:207], v[60:61] op_sel_hi:[1,0]
    v_pk_mul_f32 v[208:209], v[208:209], v[60:61] op_sel_hi:[1,0]
    v_pk_mul_f32 v[210:211], v[210:211], v[60:61] op_sel_hi:[1,0]
    ds_read_b64_tr_b16 a[58:59], v66 offset:48128
    v_cvt_pk_bf16_f32 v236, v196, v197
    v_cvt_pk_bf16_f32 v237, v198, v199
    v_cvt_pk_bf16_f32 v238, v200, v201
    ds_read_b64_tr_b16 a[60:61], v67 offset:47104
    v_cvt_pk_bf16_f32 v239, v202, v203
    v_cvt_pk_bf16_f32 v240, v204, v205
    v_cvt_pk_bf16_f32 v241, v206, v207
    ds_read_b64_tr_b16 a[62:63], v67 offset:48128
    v_cvt_pk_bf16_f32 v242, v208, v209
    v_cvt_pk_bf16_f32 v243, v210, v211
    s_mov_b64 vcc, 0x3f80
    v_lshlrev_b64 v[78:79], v2, vcc
    v_bfe_u32 v80, v1, 2, 2
    v_cmp_eq_u32 vcc, 0, v80
    s_nop 1
    v_cndmask_b32 v108, 0, v78, vcc
    v_cndmask_b32 v109, 0, v79, vcc
    v_cmp_eq_u32 vcc, 1, v80
    s_nop 1
    v_cndmask_b32 v110, 0, v78, vcc
    v_cndmask_b32 v111, 0, v79, vcc
    v_cmp_eq_u32 vcc, 2, v80
    s_nop 1
    v_cndmask_b32 v112, 0, v78, vcc
    v_cndmask_b32 v113, 0, v79, vcc
    v_cmp_eq_u32 vcc, 3, v80
    s_nop 1
    v_cndmask_b32 v114, 0, v78, vcc
    v_cndmask_b32 v115, 0, v79, vcc
    v_max3_f32 v60, v212, v213, v214
    ds_read_b64_tr_b16 a[64:65], v66 offset:49152
    v_max3_f32 v61, v215, v216, v217
    ds_read_b64_tr_b16 a[66:67], v66 offset:50176
    v_max3_f32 v60, v60, v218, v219
    v_max3_f32 v61, v61, v220, v221
    ds_read_b64_tr_b16 a[68:69], v67 offset:49152
    v_max3_f32 v60, v60, v222, v223
    v_max3_f32 v61, v61, v224, v225
    ds_read_b64_tr_b16 a[70:71], v67 offset:50176
    v_max3_f32 v60, v60, v226, v227
    v_max_f32 v60, v60, v61
    ds_read_b64_tr_b16 a[72:73], v66 offset:51200
    v_mul_f32 v60, 0xbfb8aa3b, v60
    v_pk_fma_f32 v[212:213], v[212:213], s[70:71], v[60:61] op_sel_hi:[1,0,0]
    ds_read_b64_tr_b16 a[74:75], v66 offset:52224
    v_pk_fma_f32 v[214:215], v[214:215], s[70:71], v[60:61] op_sel_hi:[1,0,0]
    ds_read_b64_tr_b16 a[76:77], v67 offset:51200
    v_pk_fma_f32 v[216:217], v[216:217], s[70:71], v[60:61] op_sel_hi:[1,0,0]
    v_pk_fma_f32 v[218:219], v[218:219], s[70:71], v[60:61] op_sel_hi:[1,0,0]
    ds_read_b64_tr_b16 a[78:79], v67 offset:52224
    v_pk_fma_f32 v[220:221], v[220:221], s[70:71], v[60:61] op_sel_hi:[1,0,0]
    v_pk_fma_f32 v[222:223], v[222:223], s[70:71], v[60:61] op_sel_hi:[1,0,0]
    ds_read_b64_tr_b16 a[80:81], v66 offset:53248
    v_pk_fma_f32 v[224:225], v[224:225], s[70:71], v[60:61] op_sel_hi:[1,0,0]
    v_pk_fma_f32 v[226:227], v[226:227], s[70:71], v[60:61] op_sel_hi:[1,0,0]
    ds_read_b64_tr_b16 a[82:83], v66 offset:54272
    v_exp_f32 v212, v212
    buffer_load_dword v148, v69, s[52:55], 0 offen sc1
    v_exp_f32 v213, v213
    ds_read_b64_tr_b16 a[84:85], v67 offset:53248
    v_exp_f32 v214, v214
    ds_read_b64_tr_b16 a[86:87], v67 offset:54272
    v_exp_f32 v215, v215
    buffer_load_dword v152, v69, s[52:55], s79 offen sc1
    v_exp_f32 v216, v216
    ds_read_b64_tr_b16 a[88:89], v66 offset:55296
    v_exp_f32 v217, v217
    v_exp_f32 v218, v218
    ds_read_b64_tr_b16 a[90:91], v66 offset:56320
    buffer_load_dword v156, v69, s[52:55], s80 offen sc1
    v_exp_f32 v219, v219
    v_exp_f32 v220, v220
    ds_read_b64_tr_b16 a[92:93], v67 offset:55296
    v_exp_f32 v221, v221
    v_exp_f32 v222, v222
    buffer_load_dword v160, v69, s[52:55], s81 offen sc1
    ds_read_b64_tr_b16 a[94:95], v67 offset:56320
    v_exp_f32 v223, v223
    v_exp_f32 v224, v224
    ds_read_b64_tr_b16 a[96:97], v66 offset:57344
    v_exp_f32 v225, v225
    ds_read_b64_tr_b16 a[98:99], v66 offset:58368
    s_add_u32 m0, s4, 0
    s_mul_i32 s84, s73, 43
    buffer_load_dwordx4 v5, s[56:59], s84 offen offset:0 lds
    v_exp_f32 v226, v226
    v_exp_f32 v227, v227
    ds_read_b64_tr_b16 a[100:101], v67 offset:57344
    v_pk_add_f32 v[60:61], v[212:213], v[214:215]
    v_pk_add_f32 v[62:63], v[216:217], v[218:219]
    buffer_load_dwordx4 v6, s[56:59], s84 offen offset:1024 lds
    ds_read_b64_tr_b16 a[102:103], v67 offset:58368
    v_pk_add_f32 v[60:61], v[60:61], v[220:221]
    v_pk_add_f32 v[62:63], v[62:63], v[222:223]
    ds_read_b64_tr_b16 a[104:105], v66 offset:59392
    v_pk_add_f32 v[60:61], v[60:61], v[224:225]
    buffer_load_dwordx4 v7, s[56:59], s84 offen offset:2048 lds
    v_pk_add_f32 v[62:63], v[62:63], v[226:227]
    ds_read_b64_tr_b16 a[106:107], v66 offset:60416
    v_pk_add_f32 v[60:61], v[60:61], v[62:63]
    ds_read_b64_tr_b16 a[108:109], v67 offset:59392
L_page_3:
    s_cbranch_execz L_page_5
    v_add_f32 v60, v60, v61
    buffer_load_dwordx4 v[36:39], v20, s[8:11], s36 offen offset:0
    v_rcp_f32 v60, v60
    ds_read_b64_tr_b16 a[110:111], v67 offset:60416
    v_pk_mul_f32 v[212:213], v[212:213], v[60:61] op_sel_hi:[1,0]
    v_pk_mul_f32 v[214:215], v[214:215], v[60:61] op_sel_hi:[1,0]
    ds_read_b64_tr_b16 a[112:113], v66 offset:61440
    v_pk_mul_f32 v[216:217], v[216:217], v[60:61] op_sel_hi:[1,0]
    buffer_load_dwordx4 v[40:43], v20, s[8:11], s36 offen offset:32
    v_pk_mul_f32 v[218:219], v[218:219], v[60:61] op_sel_hi:[1,0]
    ds_read_b64_tr_b16 a[114:115], v66 offset:62464
    v_pk_mul_f32 v[220:221], v[220:221], v[60:61] op_sel_hi:[1,0]
    v_pk_mul_f32 v[222:223], v[222:223], v[60:61] op_sel_hi:[1,0]
    ds_read_b64_tr_b16 a[116:117], v67 offset:61440
    s_add_u32 m0, s4, 12288
    s_mul_i32 s84, s73, 43
    s_add_u32 s84, s84, 88064
    buffer_load_dwordx4 v5, s[56:59], s84 offen offset:0 lds
    v_pk_mul_f32 v[224:225], v[224:225], v[60:61] op_sel_hi:[1,0]
    ds_read_b64_tr_b16 a[118:119], v67 offset:62464
    v_pk_mul_f32 v[226:227], v[226:227], v[60:61] op_sel_hi:[1,0]
    v_cvt_pk_bf16_f32 v244, v212, v213
    ds_read_b64_tr_b16 a[120:121], v66 offset:63488
    buffer_load_dwordx4 v6, s[56:59], s84 offen offset:1024 lds
    v_cvt_pk_bf16_f32 v245, v214, v215
    v_cvt_pk_bf16_f32 v246, v216, v217
    ds_read_b64_tr_b16 a[122:123], v66 offset:64512
    v_cvt_pk_bf16_f32 v247, v218, v219
    v_cvt_pk_bf16_f32 v248, v220, v221
    buffer_load_dwordx4 v7, s[56:59], s84 offen offset:2048 lds
    ds_read_b64_tr_b16 a[124:125], v67 offset:63488
    v_cvt_pk_bf16_f32 v249, v222, v223
    v_cvt_pk_bf16_f32 v250, v224, v225
    ds_read_b64_tr_b16 a[126:127], v67 offset:64512
    v_cvt_pk_bf16_f32 v251, v226, v227
    s_mov_b32 s63, 0x00010001
    s_mov_b32 s67, 0
L_kvchk_23:
    s_waitcnt vmcnt(20)
    v_xor_b32 v164, v81, v164
    v_xor_b32 v165, v82, v165
    v_xor_b32 v166, v83, v166
    v_xor_b32 v167, v84, v167
    v_or3_b32 v116, v164, v165, 0
    v_or3_b32 v117, v166, v167, 0
    v_mfma_f32_16x16x32_bf16 v[132:135], v[108:111], v[164:167], 0
    s_waitcnt vmcnt(19)
    v_xor_b32 v168, v81, v168
    v_xor_b32 v169, v82, v169
    v_xor_b32 v170, v83, v170
    v_xor_b32 v171, v84, v171
    v_or3_b32 v116, v168, v169, v116
    v_or3_b32 v117, v170, v171, v117
    v_mfma_f32_16x16x32_bf16 v[132:135], v[112:115], v[168:171], v[132:135]
    s_waitcnt vmcnt(18)
    v_xor_b32 v172, v81, v172
    v_xor_b32 v173, v82, v173
    v_xor_b32 v174, v83, v174
    v_xor_b32 v175, v84, v175
    v_or3_b32 v116, v172, v173, v116
    v_or3_b32 v117, v174, v175, v117
    v_mfma_f32_16x16x32_bf16 v[132:135], v[108:111], v[172:175], v[132:135]
    s_waitcnt vmcnt(17)
    v_xor_b32 v176, v81, v176
    v_xor_b32 v177, v82, v177
    v_xor_b32 v178, v83, v178
    v_xor_b32 v179, v84, v179
    v_or3_b32 v116, v176, v177, v116
    v_or3_b32 v117, v178, v179, v117
    v_mfma_f32_16x16x32_bf16 v[132:135], v[112:115], v[176:179], v[132:135]
    s_waitcnt vmcnt(16)
    v_xor_b32 v180, v81, v180
    v_xor_b32 v181, v82, v181
    v_xor_b32 v182, v83, v182
    v_xor_b32 v183, v84, v183
    v_or3_b32 v116, v180, v181, v116
    v_or3_b32 v117, v182, v183, v117
    v_mfma_f32_16x16x32_bf16 v[132:135], v[108:111], v[180:183], v[132:135]
    s_waitcnt vmcnt(15)
    v_xor_b32 v184, v81, v184
    v_xor_b32 v185, v82, v185
    v_xor_b32 v186, v83, v186
    v_xor_b32 v187, v84, v187
    v_or3_b32 v116, v184, v185, v116
    v_or3_b32 v117, v186, v187, v117
    v_mfma_f32_16x16x32_bf16 v[132:135], v[112:115], v[184:187], v[132:135]
    s_waitcnt vmcnt(14)
    v_xor_b32 v188, v81, v188
    v_xor_b32 v189, v82, v189
    v_xor_b32 v190, v83, v190
    v_xor_b32 v191, v84, v191
    v_or3_b32 v116, v188, v189, v116
    v_or3_b32 v117, v190, v191, v117
    v_mfma_f32_16x16x32_bf16 v[132:135], v[108:111], v[188:191], v[132:135]
    s_waitcnt vmcnt(13)
    v_xor_b32 v192, v81, v192
    v_xor_b32 v193, v82, v193
    v_xor_b32 v194, v83, v194
    v_xor_b32 v195, v84, v195
    v_or3_b32 v116, v192, v193, v116
    v_or3_b32 v117, v194, v195, v117
    v_mfma_f32_16x16x32_bf16 v[132:135], v[112:115], v[192:195], v[132:135]
    s_waitcnt vmcnt(12)
    v_xor_b32 v136, s48, v136
    v_xor_b32 v137, s49, v137
    v_xor_b32 v138, s50, v138
    v_xor_b32 v139, s51, v139
    v_or3_b32 v120, v136, v137, v138
    v_or_b32 v120, v120, v139
    v_permlane32_swap_b32 v136, v138
    v_permlane32_swap_b32 v137, v139
    v_pk_add_f32 v[136:137], v[136:137], v[138:139]
    s_nop 1
    v_permlane16_swap_b32 v136, v137
    v_add_f32 v136, v136, v137
    s_nop 1
    v_add_f32_dpp v136, v136, v136 row_ror:8 row_mask:0xf bank_mask:0xf
    s_nop 1
    v_add_f32_dpp v136, v136, v136 row_ror:4 row_mask:0xf bank_mask:0xf
    v_cvt_pk_bf16_f32 v136, v136, v136
    ds_write_b16 v74, v136
    v_bitop3_b32 v116, v116, v117, s63 bitop3:0xa8
    v_lshl_or_b32 v116, v120, 24, v116
    v_cmp_ne_u32 vcc, 0, v116
    s_cbranch_vccnz L_kvrt_24
L_kvok_25:
    v_cvt_pk_bf16_f32 v132, v132, v133
    v_cvt_pk_bf16_f32 v133, v134, v135
    ds_write_b64 v73, v[132:133]
    s_waitcnt lgkmcnt(0)
    s_barrier
    ds_read_b64 v[164:165], v75 offset:0
    ds_read_b64 v[166:167], v75 offset:544
    ds_read_b64 v[168:169], v75 offset:1088
    ds_read_b64 v[170:171], v75 offset:1632
    ds_read_b64 v[172:173], v76 offset:0
    ds_read_b64 v[174:175], v76 offset:544
    ds_read_b64 v[176:177], v76 offset:1088
    ds_read_b64 v[178:179], v76 offset:1632
    s_waitcnt lgkmcnt(6)
    v_mfma_f32_32x32x16_bf16 v[196:211], v[164:167], v[236:239], 0
    s_waitcnt lgkmcnt(4)
    v_mfma_f32_32x32x16_bf16 v[196:211], v[168:171], v[240:243], v[196:211]
    s_waitcnt lgkmcnt(2)
    v_mfma_f32_32x32x16_bf16 v[212:227], v[172:175], v[244:247], 0
    s_waitcnt lgkmcnt(0)
    v_mfma_f32_32x32x16_bf16 v[212:227], v[176:179], v[248:251], v[212:227]
    s_nop 7
    v_add_f32 v204, 0x358637bd, v204
    v_rcp_f32 v204, v204
    s_nop 0
    v_pk_mul_f32 v[196:197], v[196:197], v[204:205] op_sel_hi:[1,0]
    v_pk_mul_f32 v[198:199], v[198:199], v[204:205] op_sel_hi:[1,0]
    v_pk_mul_f32 v[200:201], v[200:201], v[204:205] op_sel_hi:[1,0]
    v_pk_mul_f32 v[202:203], v[202:203], v[204:205] op_sel_hi:[1,0]
    v_cvt_pk_bf16_f32 v228, v196, v197
    v_cvt_pk_bf16_f32 v229, v198, v199
    v_cvt_pk_bf16_f32 v230, v200, v201
    v_cvt_pk_bf16_f32 v231, v202, v203
    s_cmp_lg_u32 s28, 0
    s_cbranch_scc1 L_far_26
    buffer_store_dwordx4 v[228:231], v2, s[16:19], s82 offen offset:0
L_back_27:
    v_add_f32 v212, 0x358637bd, v212
    v_rcp_f32 v212, v212
    s_nop 0
    v_pk_mul_f32 v[220:221], v[220:221], v[212:213] op_sel_hi:[1,0]
    v_pk_mul_f32 v[222:223], v[222:223], v[212:213] op_sel_hi:[1,0]
    v_pk_mul_f32 v[224:225], v[224:225], v[212:213] op_sel_hi:[1,0]
    v_pk_mul_f32 v[226:227], v[226:227], v[212:213] op_sel_hi:[1,0]
    v_cvt_pk_bf16_f32 v232, v220, v221
    v_cvt_pk_bf16_f32 v233, v222, v223
    v_cvt_pk_bf16_f32 v234, v224, v225
    v_cvt_pk_bf16_f32 v235, v226, v227
    s_cbranch_scc1 L_far_28
    buffer_store_dwordx4 v[232:235], v2, s[16:19], s82 offen offset:1024
L_back_29:
    s_add_u32 m0, s4, 24576
    s_mul_i32 s84, s3, 43
    buffer_load_dwordx4 v5, s[56:59], s84 offen offset:0 lds
    buffer_load_dwordx4 v6, s[56:59], s84 offen offset:1024 lds
    buffer_load_dwordx4 v7, s[56:59], s84 offen offset:2048 lds
    s_add_u32 m0, s4, 36864
    s_add_u32 s84, s84, 88064
    buffer_load_dwordx4 v5, s[56:59], s84 offen offset:0 lds
    buffer_load_dwordx4 v6, s[56:59], s84 offen offset:1024 lds
    buffer_load_dwordx4 v7, s[56:59], s84 offen offset:2048 lds
    s_waitcnt vmcnt(19)
    v_xor_b32 v148, v77, v148
    s_waitcnt vmcnt(18)
    v_xor_b32 v152, v77, v152
    s_waitcnt vmcnt(17)
    v_xor_b32 v156, v77, v156
    s_waitcnt vmcnt(16)
    v_xor_b32 v160, v77, v160
    v_or3_b32 v60, v148, v152, v156
    v_or_b32 v60, v60, v160
    v_and_b32 v60, 0xff, v60
    v_cmp_ne_u32 vcc, 0, v60
    s_cbranch_vccz L_rtok_31
    s_mov_b32 s67, 0
L_rt_30:
    buffer_load_dword v148, v69, s[52:55], 0 offen sc1
    buffer_load_dword v152, v69, s[52:55], s79 offen sc1
    buffer_load_dword v156, v69, s[52:55], s80 offen sc1
    buffer_load_dword v160, v69, s[52:55], s81 offen sc1
    s_add_u32 s67, s67, 1
    s_waitcnt vmcnt(0)
    v_xor_b32 v148, v77, v148
    v_xor_b32 v152, v77, v152
    v_xor_b32 v156, v77, v156
    v_xor_b32 v160, v77, v160
    v_or3_b32 v60, v148, v152, v156
    v_or_b32 v60, v60, v160
    v_and_b32 v60, 0xff, v60
    v_cmp_ne_u32 vcc, 0, v60
    s_cbranch_vccz L_rtok_31
    s_cmp_lt_u32 s67, 20000
    s_cbranch_scc1 L_rt_30
L_rtok_31:
    s_cmp_eq_u32 s62, 2
    s_cselect_b32 s63, 1.0, 0
    v_mov_b32 v62, s63
    s_lshl_b32 s63, s62, 8
    s_add_u32 s63, s63, 161792
    v_add_u32 v69, s63, v91
    v_add_f32 v148, v148, v152
    v_add_f32 v156, v156, v160
    v_add_f32 v148, v148, v156
    v_cvt_pk_bf16_f32 v148, 0, v148
    v_add_f32 v148, v62, v148
    v_cvt_pk_bf16_f32 v148, 0, v148
    ds_write_b32 v69, v148
    s_waitcnt lgkmcnt(0)
    s_add_u32 s75, s72, 3
    v_mov_b32 v21, s75
    s_cmp_lg_u32 s29, 0
    s_waitcnt vmcnt(6)
    s_barrier
    s_cbranch_scc1 L_sig_32
    s_mov_b64 exec, 1
    buffer_store_dword v21, off, s[52:55], s71
    s_mov_b64 exec, -1
L_sig_32:
    s_cmp_eq_u32 s29, 2
    s_cbranch_scc1 L_far_33
L_back_34:
    s_cmp_lg_u32 s61, 15
    s_cbranch_scc1 L_novec_35
    buffer_load_dwordx4 v[116:119], v68, s[52:55], 0 offen sc1
    buffer_load_dwordx4 v[120:123], v68, s[52:55], s79 offen sc1
    buffer_load_dwordx4 v[124:127], v68, s[52:55], s80 offen sc1
    buffer_load_dwordx4 v[128:131], v68, s[52:55], s81 offen sc1
    s_cmp_lg_u32 s2, 255
    s_cbranch_scc1 L_novec_35
    s_add_u32 s83, s83, 8
    v_mov_b32 v60, s83
    s_mov_b32 s63, 36864
    buffer_store_dword v60, off, s[52:55], s63 sc1
L_novec_35:
    s_add_u32 m0, s4, 122880
    s_mul_i32 s84, s31, 43
    s_add_u32 s84, s84, 88064
    buffer_load_dwordx4 v5, s[56:59], s84 offen offset:0 lds
    buffer_load_dwordx4 v6, s[56:59], s84 offen offset:1024 lds
    buffer_load_dwordx4 v7, s[56:59], s84 offen offset:2048 lds
    ds_read_b64_tr_b16 a[128:129], v14 offset:36864
    ds_read_b64_tr_b16 a[130:131], v14 offset:38400
    ds_read_b64_tr_b16 a[132:133], v15 offset:36896
    ds_read_b64_tr_b16 a[134:135], v15 offset:38432
    ds_read_b64_tr_b16 a[136:137], v14 offset:36928
    ds_read_b64_tr_b16 a[138:139], v14 offset:38464
    ds_read_b64_tr_b16 a[140:141], v15 offset:36960
    ds_read_b64_tr_b16 a[142:143], v15 offset:38496
    ds_read_b64_tr_b16 a[144:145], v14 offset:36992
    ds_read_b64_tr_b16 a[146:147], v14 offset:38528
    ds_read_b64_tr_b16 a[148:149], v15 offset:37024
    ds_read_b64_tr_b16 a[150:151], v15 offset:38560
    ds_read_b64_tr_b16 a[152:153], v14 offset:43008
    ds_read_b64_tr_b16 a[154:155], v14 offset:44544
    ds_read_b64_tr_b16 a[156:157], v15 offset:43040
    ds_read_b64_tr_b16 a[158:159], v15 offset:44576
    ds_read_b64_tr_b16 a[160:161], v14 offset:43072
    ds_read_b64_tr_b16 a[162:163], v14 offset:44608
    ds_read_b64_tr_b16 a[164:165], v15 offset:43104
    ds_read_b64_tr_b16 a[166:167], v15 offset:44640
    ds_read_b64_tr_b16 a[168:169], v14 offset:43136
    ds_read_b64_tr_b16 a[170:171], v14 offset:44672
    ds_read_b64_tr_b16 a[172:173], v15 offset:43168
    ds_read_b64_tr_b16 a[174:175], v15 offset:44704
    ds_read_b64_tr_b16 a[176:177], v14 offset:49152
    ds_read_b64_tr_b16 a[178:179], v14 offset:50688
    ds_read_b64_tr_b16 a[180:181], v15 offset:49184
    ds_read_b64_tr_b16 a[182:183], v15 offset:50720
    ds_read_b64_tr_b16 a[184:185], v14 offset:49216
    ds_read_b64_tr_b16 a[186:187], v14 offset:50752
    ds_read_b64_tr_b16 a[188:189], v15 offset:49248
    ds_read_b64_tr_b16 a[190:191], v15 offset:50784
    ds_read_b64_tr_b16 a[192:193], v14 offset:49280
    ds_read_b64_tr_b16 a[194:195], v14 offset:50816
    ds_read_b64_tr_b16 a[196:197], v15 offset:49312
    ds_read_b64_tr_b16 a[198:199], v15 offset:50848
    ds_read_b64_tr_b16 a[200:201], v14 offset:55296
    ds_read_b64_tr_b16 a[202:203], v14 offset:56832
    ds_read_b64_tr_b16 a[204:205], v15 offset:55328
    ds_read_b64_tr_b16 a[206:207], v15 offset:56864
    ds_read_b64_tr_b16 a[208:209], v14 offset:55360
    ds_read_b64_tr_b16 a[210:211], v14 offset:56896
    ds_read_b64_tr_b16 a[212:213], v15 offset:55392
    ds_read_b64_tr_b16 a[214:215], v15 offset:56928
    ds_read_b64_tr_b16 a[216:217], v14 offset:55424
    ds_read_b64_tr_b16 a[218:219], v14 offset:56960
    ds_read_b64_tr_b16 a[220:221], v15 offset:55456
    ds_read_b64_tr_b16 a[222:223], v15 offset:56992
    s_cmp_lg_u32 s61, 15
    s_cbranch_scc1 L_novec2_36
    s_waitcnt vmcnt(3)
    v_xor_b32 v116, s48, v116
    v_xor_b32 v117, s49, v117
    v_xor_b32 v118, s50, v118
    v_xor_b32 v119, s51, v119
    s_waitcnt vmcnt(3)
    v_xor_b32 v120, s48, v120
    v_xor_b32 v121, s49, v121
    v_xor_b32 v122, s50, v122
    v_xor_b32 v123, s51, v123
    s_waitcnt vmcnt(3)
    v_xor_b32 v124, s48, v124
    v_xor_b32 v125, s49, v125
    v_xor_b32 v126, s50, v126
    v_xor_b32 v127, s51, v127
    s_waitcnt vmcnt(3)
    v_xor_b32 v128, s48, v128
    v_xor_b32 v129, s49, v129
    v_xor_b32 v130, s50, v130
    v_xor_b32 v131, s51, v131
    v_or3_b32 v60, v116, v117, v118
    v_or3_b32 v61, v119, v120, v121
    v_or3_b32 v60, v60, v122, v123
    v_or3_b32 v61, v61, v124, v125
    v_or3_b32 v60, v60, v126, v127
    v_or3_b32 v61, v61, v128, v129
    v_or3_b32 v60, v60, v130, v131
    v_or_b32 v60, v60, v61
    v_and_b32 v60, 0xff, v60
    v_cmp_ne_u32 vcc, 0, v60
    s_cbranch_vccz L_rtok_38
    s_mov_b32 s67, 0
L_rt_37:
    buffer_load_dwordx4 v[116:119], v68, s[52:55], 0 offen sc1
    buffer_load_dwordx4 v[120:123], v68, s[52:55], s79 offen sc1
    buffer_load_dwordx4 v[124:127], v68, s[52:55], s80 offen sc1
    buffer_load_dwordx4 v[128:131], v68, s[52:55], s81 offen sc1
    s_add_u32 s67, s67, 1
    s_waitcnt vmcnt(0)
    v_xor_b32 v116, s48, v116
    v_xor_b32 v117, s49, v117
    v_xor_b32 v118, s50, v118
    v_xor_b32 v119, s51, v119
    v_xor_b32 v120, s48, v120
    v_xor_b32 v121, s49, v121
    v_xor_b32 v122, s50, v122
    v_xor_b32 v123, s51, v123
    v_xor_b32 v124, s48, v124
    v_xor_b32 v125, s49, v125
    v_xor_b32 v126, s50, v126
    v_xor_b32 v127, s51, v127
    v_xor_b32 v128, s48, v128
    v_xor_b32 v129, s49, v129
    v_xor_b32 v130, s50, v130
    v_xor_b32 v131, s51, v131
    v_or3_b32 v60, v116, v117, v118
    v_or3_b32 v61, v119, v120, v121
    v_or3_b32 v60, v60, v122, v123
    v_or3_b32 v61, v61, v124, v125
    v_or3_b32 v60, v60, v126, v127
    v_or3_b32 v61, v61, v128, v129
    v_or3_b32 v60, v60, v130, v131
    v_or_b32 v60, v60, v61
    v_and_b32 v60, 0xff, v60
    v_cmp_ne_u32 vcc, 0, v60
    s_cbranch_vccz L_rtok_38
    s_cmp_lt_u32 s67, 20000
    s_cbranch_scc1 L_rt_37
L_rtok_38:
    v_cvt_f32_u32 v62, s76
    v_and_b32 v63, 0x3c, v1
    v_lshlrev_b32 v63, 3, v63
    v_and_b32 v64, 1, v1
    v_lshl_add_u32 v63, v64, 4, v63
    v_and_b32 v64, 2, v1
    v_lshl_add_u32 v63, v64, 2, v63
    s_lshl_b32 s63, s62, 9
    s_lshr_b32 s64, s73, 5
    s_sub_u32 s63, s63, s64
    v_add_u32 v63, s63, v63
    v_and_b32 v63, 0x3ff, v63
    s_lshl_b32 s63, s76, 10
    s_add_u32 s63, s63, 159744
    v_add_u32 v63, s63, v63
    v_pk_add_f32 v[116:117], v[116:117], v[120:121]
    v_pk_add_f32 v[124:125], v[124:125], v[128:129]
    v_pk_add_f32 v[118:119], v[118:119], v[122:123]
    v_pk_add_f32 v[126:127], v[126:127], v[130:131]
    v_pk_add_f32 v[116:117], v[116:117], v[124:125]
    v_pk_add_f32 v[118:119], v[118:119], v[126:127]
    v_cvt_pk_bf16_f32 v116, 0, v116
    v_cvt_pk_bf16_f32 v117, 0, v117
    v_cvt_pk_bf16_f32 v118, 0, v118
    v_cvt_pk_bf16_f32 v119, 0, v119
    v_add_f32 v116, v62, v116
    v_add_f32 v117, v62, v117
    v_add_f32 v118, v62, v118
    v_add_f32 v119, v62, v119
    v_cvt_pk_bf16_f32 v116, 0, v116
    v_cvt_pk_bf16_f32 v117, 0, v117
    v_cvt_pk_bf16_f32 v118, 0, v118
    v_cvt_pk_bf16_f32 v119, 0, v119
    v_cvt_pk_bf16_f32 v116, v116, v117
    v_cvt_pk_bf16_f32 v117, v118, v119
    ds_write_b64 v63, v[116:117]
L_novec2_36:
    s_mul_i32 s65, s77, 32768
    s_add_u32 s65, s65, 131072
    v_add_u32 v208, s65, v2
    s_mov_b64 exec, 65535
    s_mov_b32 s67, 0
    s_add_u32 s75, s72, 3
L_poll_39:
    buffer_load_dword v209, v18, s[52:55], 0 offen sc1
    s_add_u32 s67, s67, 1
    s_waitcnt vmcnt(0)
    v_subrev_u32 v209, s75, v209
    v_cmp_lt_u32 vcc, 5, v209
    s_cbranch_vccz L_polld_40
    s_cmp_lt_u32 s67, 20000
    s_cbranch_scc1 L_poll_39
L_polld_40:
    s_mov_b64 exec, -1
    buffer_load_dwordx4 v[60:63], v208, s[16:19], s40 offen offset:0 sc1
    buffer_load_dwordx4 v[64:67], v208, s[16:19], s40 offen offset:1024 sc1
    buffer_load_dwordx4 v[68:71], v208, s[16:19], s40 offen offset:2048 sc1
    buffer_load_dwordx4 v[72:75], v208, s[16:19], s40 offen offset:3072 sc1
    buffer_load_dwordx4 v[76:79], v208, s[16:19], s41 offen offset:0 sc1
    buffer_load_dwordx4 v[80:83], v208, s[16:19], s41 offen offset:1024 sc1
    buffer_load_dwordx4 v[84:87], v208, s[16:19], s41 offen offset:2048 sc1
    buffer_load_dwordx4 v[88:91], v208, s[16:19], s41 offen offset:3072 sc1
    buffer_load_dwordx4 v[92:95], v208, s[16:19], s42 offen offset:0 sc1
    v_lshrrev_b32 v204, 5, v1
    s_lshl_b32 s63, s76, 7
    s_add_u32 s63, s63, 161792
    v_lshl_add_u32 v19, v204, 4, s63
    ds_read_b128 v[156:159], v19 offset:0
    ds_read_b128 v[172:175], v19 offset:512
    ds_read_b128 v[160:163], v19 offset:32
    ds_read_b128 v[176:179], v19 offset:544
    ds_read_b128 v[164:167], v19 offset:64
    ds_read_b128 v[180:183], v19 offset:576
    ds_read_b128 v[168:171], v19 offset:96
    ds_read_b128 v[184:187], v19 offset:608
    v_permlane32_swap_b32 v36, v38
    v_permlane32_swap_b32 v37, v39
    v_permlane32_swap_b32 v40, v42
    v_permlane32_swap_b32 v41, v43
    v_lshlrev_b32 v28, 16, v36
    v_and_b32 v29, 0xffff0000, v36
    v_lshlrev_b32 v30, 16, v37
    v_and_b32 v31, 0xffff0000, v37
    v_lshlrev_b32 v32, 16, v38
    v_and_b32 v33, 0xffff0000, v38
    v_lshlrev_b32 v34, 16, v39
    v_and_b32 v35, 0xffff0000, v39
    v_lshlrev_b32 v36, 16, v40
    v_and_b32 v37, 0xffff0000, v40
    v_lshlrev_b32 v38, 16, v41
    v_and_b32 v39, 0xffff0000, v41
    v_lshlrev_b32 v40, 16, v42
    v_and_b32 v41, 0xffff0000, v42
    v_lshlrev_b32 v42, 16, v43
    v_and_b32 v43, 0xffff0000, v43
    s_lshl_b32 s63, s62, 12
    s_add_u32 s64, s63, 143360
    v_add_u32 v205, s64, v2
    s_xor_b32 s63, s63, 8192
    s_add_u32 s64, s63, 143360
    v_add_u32 v206, s64, v2
    v_and_b32 v207, 31, v1
    v_lshlrev_b32 v207, 3, v207
    v_lshl_add_u32 v207, v204, 2, v207
    s_lshl1_add_u32 s63, s78, s76
    s_lshl4_add_u32 s79, s77, s63
    s_lshl_b32 s80, s79, 11
    s_lshl_b32 s63, s60, 17
    s_add_u32 s80, s80, s63
    s_lshl_b32 s79, s79, 8
    s_add_u32 s79, s79, 393216
    s_waitcnt vmcnt(8)
    v_mfma_f32_32x32x16_bf16 v[140:155], a[4:7], v[60:63], 0
    buffer_load_dwordx4 v[96:99], v208, s[16:19], s42 offen offset:1024 sc1
    v_mfma_f32_32x32x16_bf16 v[124:139], a[0:3], v[60:63], 0
    s_waitcnt vmcnt(8)
    v_mfma_f32_32x32x16_bf16 v[140:155], a[12:15], v[64:67], v[140:155]
    buffer_load_dwordx4 v[100:103], v208, s[16:19], s42 offen offset:2048 sc1
    v_mfma_f32_32x32x16_bf16 v[124:139], a[8:11], v[64:67], v[124:139]
    s_waitcnt vmcnt(8)
    v_mfma_f32_32x32x16_bf16 v[140:155], a[20:23], v[68:71], v[140:155]
    buffer_load_dwordx4 v[104:107], v208, s[16:19], s42 offen offset:3072 sc1
    v_mfma_f32_32x32x16_bf16 v[124:139], a[16:19], v[68:71], v[124:139]
    s_waitcnt vmcnt(8)
    v_mfma_f32_32x32x16_bf16 v[140:155], a[28:31], v[72:75], v[140:155]
    buffer_load_dwordx4 v[108:111], v208, s[16:19], s43 offen offset:0 sc1
    v_mfma_f32_32x32x16_bf16 v[124:139], a[24:27], v[72:75], v[124:139]
    s_waitcnt vmcnt(8)
    v_mfma_f32_32x32x16_bf16 v[140:155], a[36:39], v[76:79], v[140:155]
    buffer_load_dwordx4 v[112:115], v208, s[16:19], s43 offen offset:1024 sc1
    v_mfma_f32_32x32x16_bf16 v[124:139], a[32:35], v[76:79], v[124:139]
    s_waitcnt vmcnt(8)
    v_mfma_f32_32x32x16_bf16 v[140:155], a[44:47], v[80:83], v[140:155]
    buffer_load_dwordx4 v[116:119], v208, s[16:19], s43 offen offset:2048 sc1
    v_mfma_f32_32x32x16_bf16 v[124:139], a[40:43], v[80:83], v[124:139]
    s_waitcnt vmcnt(8)
    v_mfma_f32_32x32x16_bf16 v[140:155], a[52:55], v[84:87], v[140:155]
    buffer_load_dwordx4 v[120:123], v208, s[16:19], s43 offen offset:3072 sc1
    v_mfma_f32_32x32x16_bf16 v[124:139], a[48:51], v[84:87], v[124:139]
    s_waitcnt vmcnt(8)
    v_mfma_f32_32x32x16_bf16 v[140:155], a[60:63], v[88:91], v[140:155]
    s_add_u32 m0, s4, 49152
    s_mul_i32 s84, s6, 43
    buffer_load_dwordx4 v5, s[56:59], s84 offen offset:0 lds
    v_mfma_f32_32x32x16_bf16 v[124:139], a[56:59], v[88:91], v[124:139]
    s_waitcnt vmcnt(8)
    v_mfma_f32_32x32x16_bf16 v[140:155], a[68:71], v[92:95], v[140:155]
    buffer_load_dwordx4 v6, s[56:59], s84 offen offset:1024 lds
    v_mfma_f32_32x32x16_bf16 v[124:139], a[64:67], v[92:95], v[124:139]
    s_waitcnt vmcnt(8)
    v_mfma_f32_32x32x16_bf16 v[140:155], a[76:79], v[96:99], v[140:155]
    buffer_load_dwordx4 v7, s[56:59], s84 offen offset:2048 lds
    v_mfma_f32_32x32x16_bf16 v[124:139], a[72:75], v[96:99], v[124:139]
    s_waitcnt vmcnt(8)
    v_mfma_f32_32x32x16_bf16 v[140:155], a[84:87], v[100:103], v[140:155]
    s_add_u32 m0, s4, 61440
    s_add_u32 s84, s84, 88064
    buffer_load_dwordx4 v5, s[56:59], s84 offen offset:0 lds
    v_mfma_f32_32x32x16_bf16 v[124:139], a[80:83], v[100:103], v[124:139]
    s_waitcnt vmcnt(8)
    v_mfma_f32_32x32x16_bf16 v[140:155], a[92:95], v[104:107], v[140:155]
    buffer_load_dwordx4 v6, s[56:59], s84 offen offset:1024 lds
    v_mfma_f32_32x32x16_bf16 v[124:139], a[88:91], v[104:107], v[124:139]
    s_waitcnt vmcnt(8)
    v_mfma_f32_32x32x16_bf16 v[140:155], a[100:103], v[108:111], v[140:155]
    buffer_load_dwordx4 v7, s[56:59], s84 offen offset:2048 lds
    v_mfma_f32_32x32x16_bf16 v[124:139], a[96:99], v[108:111], v[124:139]
    s_waitcnt vmcnt(8)
    v_mfma_f32_32x32x16_bf16 v[140:155], a[108:111], v[112:115], v[140:155]
    s_add_u32 m0, s4, 73728
    s_mul_i32 s84, s7, 43
    buffer_load_dwordx4 v5, s[56:59], s84 offen offset:0 lds
    v_mfma_f32_32x32x16_bf16 v[124:139], a[104:107], v[112:115], v[124:139]
    s_waitcnt vmcnt(8)
    v_mfma_f32_32x32x16_bf16 v[140:155], a[116:119], v[116:119], v[140:155]
    buffer_load_dwordx4 v6, s[56:59], s84 offen offset:1024 lds
    v_mfma_f32_32x32x16_bf16 v[124:139], a[112:115], v[116:119], v[124:139]
    s_waitcnt vmcnt(8)
    v_mfma_f32_32x32x16_bf16 v[140:155], a[124:127], v[120:123], v[140:155]
    buffer_load_dwordx4 v7, s[56:59], s84 offen offset:2048 lds
    v_mfma_f32_32x32x16_bf16 v[124:139], a[120:123], v[120:123], v[124:139]
    s_lshr_b32 s24, s2, 3
    s_lshl2_add_u32 s24, s24, s62
    v_min_u32 v254, 10, v1
    s_mul_i32 s24, s24, 11264
    v_lshlrev_b32 v254, 10, v254
    buffer_load_dword v255, v254, s[32:35], s24 offen offset:384
    s_add_u32 m0, s4, 86016
    s_mul_i32 s84, s7, 43
    s_add_u32 s84, s84, 88064
    buffer_load_dwordx4 v5, s[56:59], s84 offen offset:0 lds
    buffer_load_dwordx4 v6, s[56:59], s84 offen offset:1024 lds
    buffer_load_dwordx4 v7, s[56:59], s84 offen offset:2048 lds
    ds_write_b128 v205, v[140:143] offset:0
    ds_write_b128 v205, v[144:147] offset:1024
    ds_write_b128 v205, v[148:151] offset:2048
    ds_write_b128 v205, v[152:155] offset:3072
    s_waitcnt lgkmcnt(0)
    s_barrier
    ds_read_b128 v[188:191], v206 offset:0
    ds_read_b128 v[192:195], v206 offset:1024
    ds_read_b128 v[196:199], v206 offset:2048
    ds_read_b128 v[200:203], v206 offset:3072
    s_waitcnt lgkmcnt(3)
    v_pk_add_f32 v[124:125], v[124:125], v[188:189]
    v_pk_add_f32 v[126:127], v[126:127], v[190:191]
    s_waitcnt lgkmcnt(2)
    v_pk_add_f32 v[128:129], v[128:129], v[192:193]
    v_pk_add_f32 v[130:131], v[130:131], v[194:195]
    v_pk_fma_f32 v[28:29], v[124:125], v[156:157], v[28:29]
    v_pk_fma_f32 v[30:31], v[126:127], v[158:159], v[30:31]
    v_pk_fma_f32 v[32:33], v[128:129], v[160:161], v[32:33]
    v_pk_fma_f32 v[34:35], v[130:131], v[162:163], v[34:35]
    v_pk_mul_f32 v[172:173], v[172:173], v[28:29]
    v_pk_mul_f32 v[174:175], v[174:175], v[30:31]
    v_pk_mul_f32 v[176:177], v[176:177], v[32:33]
    v_pk_mul_f32 v[178:179], v[178:179], v[34:35]
    v_cvt_pk_bf16_f32 v140, v172, v173
    v_cvt_pk_bf16_f32 v141, v174, v175
    v_cvt_pk_bf16_f32 v142, v176, v177
    v_cvt_pk_bf16_f32 v143, v178, v179
    s_cmp_lg_u32 s28, 0
    s_cbranch_scc1 L_far_41
    buffer_store_dwordx4 v[140:143], v2, s[44:47], s80 offen offset:0
L_back_42:
    s_waitcnt lgkmcnt(1)
    v_pk_add_f32 v[132:133], v[132:133], v[196:197]
    v_pk_add_f32 v[134:135], v[134:135], v[198:199]
    s_waitcnt lgkmcnt(0)
    v_pk_add_f32 v[136:137], v[136:137], v[200:201]
    v_pk_add_f32 v[138:139], v[138:139], v[202:203]
    v_pk_fma_f32 v[36:37], v[132:133], v[164:165], v[36:37]
    v_pk_fma_f32 v[38:39], v[134:135], v[166:167], v[38:39]
    v_pk_fma_f32 v[40:41], v[136:137], v[168:169], v[40:41]
    v_pk_fma_f32 v[42:43], v[138:139], v[170:171], v[42:43]
    v_pk_mul_f32 v[180:181], v[180:181], v[36:37]
    v_pk_mul_f32 v[182:183], v[182:183], v[38:39]
    v_pk_mul_f32 v[184:185], v[184:185], v[40:41]
    v_pk_mul_f32 v[186:187], v[186:187], v[42:43]
    v_cvt_pk_bf16_f32 v144, v180, v181
    v_cvt_pk_bf16_f32 v145, v182, v183
    v_cvt_pk_bf16_f32 v146, v184, v185
    v_cvt_pk_bf16_f32 v147, v186, v187
    s_cbranch_scc1 L_far_43
    buffer_store_dwordx4 v[144:147], v2, s[44:47], s80 offen offset:1024
L_back_44:
    v_pk_add_f32 v[210:211], v[28:29], v[30:31]
    v_pk_mul_f32 v[212:213], v[28:29], v[28:29]
    v_pk_fma_f32 v[212:213], v[30:31], v[30:31], v[212:213]
    v_pk_add_f32 v[210:211], v[210:211], v[32:33]
    v_pk_fma_f32 v[212:213], v[32:33], v[32:33], v[212:213]
    v_pk_add_f32 v[210:211], v[210:211], v[34:35]
    v_pk_fma_f32 v[212:213], v[34:35], v[34:35], v[212:213]
    v_pk_add_f32 v[210:211], v[210:211], v[36:37]
    v_pk_fma_f32 v[212:213], v[36:37], v[36:37], v[212:213]
    v_pk_add_f32 v[210:211], v[210:211], v[38:39]
    v_pk_fma_f32 v[212:213], v[38:39], v[38:39], v[212:213]
    v_pk_add_f32 v[210:211], v[210:211], v[40:41]
    v_pk_fma_f32 v[212:213], v[40:41], v[40:41], v[212:213]
    v_pk_add_f32 v[210:211], v[210:211], v[42:43]
    v_pk_fma_f32 v[212:213], v[42:43], v[42:43], v[212:213]
    v_add_f32 v210, v210, v211
    v_add_f32 v211, v212, v213
    s_nop 1
    v_permlane32_swap_b32 v210, v211
    v_add_f32 v210, v210, v211
    s_cbranch_scc1 L_far_45
    buffer_store_dword v210, v207, s[16:19], s79 offen
L_back_46:
    ds_read_b64_tr_b16 a[224:225], v16 offset:0
    s_add_u32 m0, s4, 98304
    s_mul_i32 s84, s26, 43
    buffer_load_dwordx4 v5, s[56:59], s84 offen offset:0 lds
L_page_4:
    s_cbranch_execz L_page_6
    ds_read_b64_tr_b16 a[226:227], v16 offset:1536
    ds_read_b64_tr_b16 a[228:229], v17 offset:32
    ds_read_b64_tr_b16 a[230:231], v17 offset:1568
    ds_read_b64_tr_b16 a[232:233], v16 offset:64
    buffer_load_dwordx4 v6, s[56:59], s84 offen offset:1024 lds
    ds_read_b64_tr_b16 a[234:235], v16 offset:1600
    ds_read_b64_tr_b16 a[236:237], v17 offset:96
    ds_read_b64_tr_b16 a[238:239], v17 offset:1632
    ds_read_b64_tr_b16 a[240:241], v16 offset:128
    buffer_load_dwordx4 v7, s[56:59], s84 offen offset:2048 lds
    ds_read_b64_tr_b16 a[242:243], v16 offset:1664
    ds_read_b64_tr_b16 a[244:245], v17 offset:160
    ds_read_b64_tr_b16 a[246:247], v17 offset:1696
    ds_read_b64_tr_b16 a[248:249], v16 offset:6144
    s_add_u32 m0, s4, 110592
    s_add_u32 s84, s84, 88064
    buffer_load_dwordx4 v5, s[56:59], s84 offen offset:0 lds
    ds_read_b64_tr_b16 a[250:251], v16 offset:7680
    ds_read_b64_tr_b16 a[252:253], v17 offset:6176
    ds_read_b64_tr_b16 a[254:255], v17 offset:7712
    ds_read_b64_tr_b16 v[44:45], v16 offset:6208
    buffer_load_dwordx4 v6, s[56:59], s84 offen offset:1024 lds
    ds_read_b64_tr_b16 v[46:47], v16 offset:7744
    ds_read_b64_tr_b16 v[48:49], v17 offset:6240
    ds_read_b64_tr_b16 v[50:51], v17 offset:7776
    ds_read_b64_tr_b16 v[52:53], v16 offset:6272
    buffer_load_dwordx4 v7, s[56:59], s84 offen offset:2048 lds
    ds_read_b64_tr_b16 v[54:55], v16 offset:7808
    ds_read_b64_tr_b16 v[56:57], v17 offset:6304
    ds_read_b64_tr_b16 v[58:59], v17 offset:7840
    s_waitcnt lgkmcnt(0)
    s_add_u32 s75, s72, 4
    v_mov_b32 v21, s75
    s_cmp_lg_u32 s29, 0
    s_waitcnt vmcnt(6)
    s_barrier
    s_cbranch_scc1 L_sig_47
    s_mov_b64 exec, 1
    buffer_store_dword v21, off, s[52:55], s71
    s_mov_b64 exec, -1
L_sig_47:
    s_cmp_eq_u32 s29, 2
    s_cbranch_scc1 L_far_48
L_back_49:
    s_add_u32 m0, s4, 122880
    s_mul_i32 s84, s27, 43
    buffer_load_dwordx4 v5, s[56:59], s84 offen offset:0 lds
    buffer_load_dwordx4 v6, s[56:59], s84 offen offset:1024 lds
    buffer_load_dwordx4 v7, s[56:59], s84 offen offset:2048 lds
    s_and_b32 s82, s72, 0x3fff3fff
    s_cmp_eq_u32 s61, 15
    s_cbranch_scc1 L_m15_50
    ds_read_b64_tr_b16 v[156:157], v12 offset:0
    ds_read_b64_tr_b16 v[158:159], v12 offset:1536
    ds_read_b64_tr_b16 v[160:161], v13 offset:32
    ds_read_b64_tr_b16 v[162:163], v13 offset:1568
    ds_read_b64_tr_b16 v[164:165], v12 offset:64
    ds_read_b64_tr_b16 v[166:167], v12 offset:1600
    ds_read_b64_tr_b16 v[168:169], v13 offset:96
    ds_read_b64_tr_b16 v[170:171], v13 offset:1632
    ds_read_b64_tr_b16 v[172:173], v12 offset:128
    ds_read_b64_tr_b16 v[174:175], v12 offset:1664
    ds_read_b64_tr_b16 v[176:177], v13 offset:160
    ds_read_b64_tr_b16 v[178:179], v13 offset:1696
    s_lshl_b32 s63, s76, 10
    v_add_u32 v24, s63, v18
    s_lshl2_add_u32 s65, s60, s62
    s_lshl_b32 s65, s65, 15
    s_add_u32 s65, s65, 0
    v_add_u32 v25, s65, v2
    s_lshl2_add_u32 s79, s5, 393216
    s_mul_i32 s80, s62, 88064
    s_mul_i32 s64, s61, 6144
    s_add_u32 s80, s80, s64
    s_add_u32 s80, s80, 425984
    s_add_u32 s66, s80, 2048
    s_lshl_b32 s81, s61, 12
    s_add_u32 s81, s81, 1179648
    s_mov_b32 s12, s16
    s_mov_b32 s13, s17
    s_cmp_eq_u32 s61, 14
    s_cselect_b32 s14, 0, s18
    v_lshlrev_b32 v22, 3, v1
    v_and_b32 v23, 0x1ff, v2
    s_mov_b64 exec, 255
    s_mov_b32 s67, 0
    s_add_u32 s75, s72, 4
L_poll_52:
    buffer_load_dword v21, v24, s[52:55], 0 offen sc1
    s_add_u32 s67, s67, 1
    s_waitcnt vmcnt(0)
    v_subrev_u32 v21, s75, v21
    v_cmp_lt_u32 vcc, 5, v21
    s_cbranch_vccz L_polld_53
    s_cmp_lt_u32 s67, 20000
    s_cbranch_scc1 L_poll_52
L_polld_53:
    s_mov_b64 exec, -1
    buffer_load_dwordx4 a[0:3], v25, s[44:47], s73 offen offset:0 sc1
    buffer_load_dwordx4 a[4:7], v25, s[44:47], s73 offen offset:1024 sc1
    buffer_load_dwordx4 a[8:11], v25, s[44:47], s73 offen offset:2048 sc1
    buffer_load_dwordx4 a[12:15], v25, s[44:47], s73 offen offset:3072 sc1
    buffer_load_dwordx4 a[16:19], v25, s[44:47], s3 offen offset:0 sc1
    buffer_load_dwordx4 a[20:23], v25, s[44:47], s3 offen offset:1024 sc1
    s_barrier
    s_waitcnt vmcnt(5) lgkmcnt(6)
    v_mfma_f32_32x32x16_bf16 v[60:75], v[156:159], a[0:3], 0
    ds_read_b64_tr_b16 v[180:181], v12 offset:6144
    ds_read_b64_tr_b16 v[182:183], v12 offset:7680
    buffer_load_dwordx4 a[24:27], v25, s[44:47], s3 offen offset:2048 sc1
    v_mfma_f32_32x32x16_bf16 v[76:91], v[160:163], a[0:3], 0
    ds_read_b64_tr_b16 v[184:185], v13 offset:6176
    ds_read_b64_tr_b16 v[186:187], v13 offset:7712
    v_mfma_f32_32x32x16_bf16 v[92:107], v[164:167], a[0:3], 0
    ds_read_b64_tr_b16 v[156:157], v12 offset:6208
    ds_read_b64_tr_b16 v[158:159], v12 offset:7744
    buffer_load_dwordx4 a[28:31], v25, s[44:47], s3 offen offset:3072 sc1
    s_waitcnt lgkmcnt(6)
    v_mfma_f32_32x32x16_bf16 v[108:123], v[168:171], a[0:3], 0
    ds_read_b64_tr_b16 v[160:161], v13 offset:6240
    ds_read_b64_tr_b16 v[162:163], v13 offset:7776
    v_mfma_f32_32x32x16_bf16 v[124:139], v[172:175], a[0:3], 0
    ds_read_b64_tr_b16 v[164:165], v12 offset:6272
    ds_read_b64_tr_b16 v[166:167], v12 offset:7808
    buffer_load_dwordx4 a[32:35], v25, s[44:47], s6 offen offset:0 sc1
    v_mfma_f32_32x32x16_bf16 v[140:155], v[176:179], a[0:3], 0
    ds_read_b64_tr_b16 v[168:169], v13 offset:6304
    ds_read_b64_tr_b16 v[170:171], v13 offset:7840
    s_waitcnt vmcnt(7) lgkmcnt(6)
    v_mfma_f32_32x32x16_bf16 v[60:75], v[180:183], a[4:7], v[60:75]
    ds_read_b64_tr_b16 v[172:173], v12 offset:12288
    ds_read_b64_tr_b16 v[174:175], v12 offset:13824
    v_mfma_f32_32x32x16_bf16 v[76:91], v[184:187], a[4:7], v[76:91]
    ds_read_b64_tr_b16 v[176:177], v13 offset:12320
    ds_read_b64_tr_b16 v[178:179], v13 offset:13856
    buffer_load_dwordx4 a[36:39], v25, s[44:47], s6 offen offset:1024 sc1
    v_mfma_f32_32x32x16_bf16 v[92:107], v[156:159], a[4:7], v[92:107]
    ds_read_b64_tr_b16 v[180:181], v12 offset:12352
    ds_read_b64_tr_b16 v[182:183], v12 offset:13888
    s_waitcnt lgkmcnt(6)
    v_mfma_f32_32x32x16_bf16 v[108:123], v[160:163], a[4:7], v[108:123]
    ds_read_b64_tr_b16 v[184:185], v13 offset:12384
    ds_read_b64_tr_b16 v[186:187], v13 offset:13920
    buffer_load_dwordx4 a[40:43], v25, s[44:47], s6 offen offset:2048 sc1
    v_mfma_f32_32x32x16_bf16 v[124:139], v[164:167], a[4:7], v[124:139]
    ds_read_b64_tr_b16 v[156:157], v12 offset:12416
    ds_read_b64_tr_b16 v[158:159], v12 offset:13952
    v_mfma_f32_32x32x16_bf16 v[140:155], v[168:171], a[4:7], v[140:155]
    ds_read_b64_tr_b16 v[160:161], v13 offset:12448
    ds_read_b64_tr_b16 v[162:163], v13 offset:13984
    s_waitcnt vmcnt(8) lgkmcnt(6)
    v_mfma_f32_32x32x16_bf16 v[60:75], v[172:175], a[8:11], v[60:75]
    ds_read_b64_tr_b16 v[164:165], v12 offset:18432
    ds_read_b64_tr_b16 v[166:167], v12 offset:19968
    buffer_load_dwordx4 a[44:47], v25, s[44:47], s6 offen offset:3072 sc1
    v_mfma_f32_32x32x16_bf16 v[76:91], v[176:179], a[8:11], v[76:91]
    ds_read_b64_tr_b16 v[168:169], v13 offset:18464
    ds_read_b64_tr_b16 v[170:171], v13 offset:20000
    v_mfma_f32_32x32x16_bf16 v[92:107], v[180:183], a[8:11], v[92:107]
    ds_read_b64_tr_b16 v[172:173], v12 offset:18496
    ds_read_b64_tr_b16 v[174:175], v12 offset:20032
    buffer_load_dwordx4 a[48:51], v25, s[44:47], s7 offen offset:0 sc1
    s_waitcnt lgkmcnt(6)
    v_mfma_f32_32x32x16_bf16 v[108:123], v[184:187], a[8:11], v[108:123]
    ds_read_b64_tr_b16 v[176:177], v13 offset:18528
    ds_read_b64_tr_b16 v[178:179], v13 offset:20064
    v_mfma_f32_32x32x16_bf16 v[124:139], v[156:159], a[8:11], v[124:139]
    ds_read_b64_tr_b16 v[180:181], v12 offset:18560
    ds_read_b64_tr_b16 v[182:183], v12 offset:20096
    buffer_load_dwordx4 a[52:55], v25, s[44:47], s7 offen offset:1024 sc1
    v_mfma_f32_32x32x16_bf16 v[140:155], v[160:163], a[8:11], v[140:155]
    ds_read_b64_tr_b16 v[184:185], v13 offset:18592
    ds_read_b64_tr_b16 v[186:187], v13 offset:20128
    s_waitcnt vmcnt(10) lgkmcnt(6)
    v_mfma_f32_32x32x16_bf16 v[60:75], v[164:167], a[12:15], v[60:75]
    ds_read_b64_tr_b16 v[156:157], v12 offset:24576
    ds_read_b64_tr_b16 v[158:159], v12 offset:26112
    v_mfma_f32_32x32x16_bf16 v[76:91], v[168:171], a[12:15], v[76:91]
    ds_read_b64_tr_b16 v[160:161], v13 offset:24608
    ds_read_b64_tr_b16 v[162:163], v13 offset:26144
    buffer_load_dwordx4 a[56:59], v25, s[44:47], s7 offen offset:2048 sc1
    v_mfma_f32_32x32x16_bf16 v[92:107], v[172:175], a[12:15], v[92:107]
    ds_read_b64_tr_b16 v[164:165], v12 offset:24640
    ds_read_b64_tr_b16 v[166:167], v12 offset:26176
    s_waitcnt lgkmcnt(6)
    v_mfma_f32_32x32x16_bf16 v[108:123], v[176:179], a[12:15], v[108:123]
    ds_read_b64_tr_b16 v[168:169], v13 offset:24672
    ds_read_b64_tr_b16 v[170:171], v13 offset:26208
    buffer_load_dwordx4 a[60:63], v25, s[44:47], s7 offen offset:3072 sc1
    v_mfma_f32_32x32x16_bf16 v[124:139], v[180:183], a[12:15], v[124:139]
    ds_read_b64_tr_b16 v[172:173], v12 offset:24704
    ds_read_b64_tr_b16 v[174:175], v12 offset:26240
    v_mfma_f32_32x32x16_bf16 v[140:155], v[184:187], a[12:15], v[140:155]
    ds_read_b64_tr_b16 v[176:177], v13 offset:24736
    ds_read_b64_tr_b16 v[178:179], v13 offset:26272
    buffer_load_dwordx4 a[64:67], v25, s[44:47], s26 offen offset:0 sc1
    s_waitcnt vmcnt(12) lgkmcnt(6)
    v_mfma_f32_32x32x16_bf16 v[60:75], v[156:159], a[16:19], v[60:75]
    ds_read_b64_tr_b16 v[180:181], v12 offset:30720
    ds_read_b64_tr_b16 v[182:183], v12 offset:32256
    v_mfma_f32_32x32x16_bf16 v[76:91], v[160:163], a[16:19], v[76:91]
    ds_read_b64_tr_b16 v[184:185], v13 offset:30752
    ds_read_b64_tr_b16 v[186:187], v13 offset:32288
    v_mfma_f32_32x32x16_bf16 v[92:107], v[164:167], a[16:19], v[92:107]
    ds_read_b64_tr_b16 v[156:157], v12 offset:30784
    ds_read_b64_tr_b16 v[158:159], v12 offset:32320
    buffer_load_dwordx4 a[68:71], v25, s[44:47], s26 offen offset:1024 sc1
    s_waitcnt lgkmcnt(6)
    v_mfma_f32_32x32x16_bf16 v[108:123], v[168:171], a[16:19], v[108:123]
    ds_read_b64_tr_b16 v[160:161], v13 offset:30816
    ds_read_b64_tr_b16 v[162:163], v13 offset:32352
    v_mfma_f32_32x32x16_bf16 v[124:139], v[172:175], a[16:19], v[124:139]
    ds_read_b64_tr_b16 v[164:165], v12 offset:30848
    ds_read_b64_tr_b16 v[166:167], v12 offset:32384
    buffer_load_dwordx4 a[72:75], v25, s[44:47], s26 offen offset:2048 sc1
    v_mfma_f32_32x32x16_bf16 v[140:155], v[176:179], a[16:19], v[140:155]
    ds_read_b64_tr_b16 v[168:169], v13 offset:30880
    ds_read_b64_tr_b16 v[170:171], v13 offset:32416
    s_waitcnt vmcnt(13) lgkmcnt(6)
    v_mfma_f32_32x32x16_bf16 v[60:75], v[180:183], a[20:23], v[60:75]
    ds_read_b64_tr_b16 v[172:173], v12 offset:36864
    ds_read_b64_tr_b16 v[174:175], v12 offset:38400
    v_mfma_f32_32x32x16_bf16 v[76:91], v[184:187], a[20:23], v[76:91]
    ds_read_b64_tr_b16 v[176:177], v13 offset:36896
    ds_read_b64_tr_b16 v[178:179], v13 offset:38432
    buffer_load_dwordx4 a[76:79], v25, s[44:47], s26 offen offset:3072 sc1
    v_mfma_f32_32x32x16_bf16 v[92:107], v[156:159], a[20:23], v[92:107]
    ds_read_b64_tr_b16 v[180:181], v12 offset:36928
    ds_read_b64_tr_b16 v[182:183], v12 offset:38464
    s_waitcnt lgkmcnt(6)
    v_mfma_f32_32x32x16_bf16 v[108:123], v[160:163], a[20:23], v[108:123]
    ds_read_b64_tr_b16 v[184:185], v13 offset:36960
    ds_read_b64_tr_b16 v[186:187], v13 offset:38496
    buffer_load_dwordx4 a[80:83], v25, s[44:47], s27 offen offset:0 sc1
    v_mfma_f32_32x32x16_bf16 v[124:139], v[164:167], a[20:23], v[124:139]
    ds_read_b64_tr_b16 v[156:157], v12 offset:36992
    ds_read_b64_tr_b16 v[158:159], v12 offset:38528
    v_mfma_f32_32x32x16_bf16 v[140:155], v[168:171], a[20:23], v[140:155]
    ds_read_b64_tr_b16 v[160:161], v13 offset:37024
    ds_read_b64_tr_b16 v[162:163], v13 offset:38560
    buffer_load_dwordx4 a[84:87], v25, s[44:47], s27 offen offset:1024 sc1
    s_waitcnt vmcnt(15) lgkmcnt(6)
    v_mfma_f32_32x32x16_bf16 v[60:75], v[172:175], a[24:27], v[60:75]
    ds_read_b64_tr_b16 v[164:165], v12 offset:43008
    ds_read_b64_tr_b16 v[166:167], v12 offset:44544
    v_mfma_f32_32x32x16_bf16 v[76:91], v[176:179], a[24:27], v[76:91]
    ds_read_b64_tr_b16 v[168:169], v13 offset:43040
    ds_read_b64_tr_b16 v[170:171], v13 offset:44576
    v_mfma_f32_32x32x16_bf16 v[92:107], v[180:183], a[24:27], v[92:107]
    ds_read_b64_tr_b16 v[172:173], v12 offset:43072
    ds_read_b64_tr_b16 v[174:175], v12 offset:44608
    buffer_load_dwordx4 a[88:91], v25, s[44:47], s27 offen offset:2048 sc1
    s_waitcnt lgkmcnt(6)
    v_mfma_f32_32x32x16_bf16 v[108:123], v[184:187], a[24:27], v[108:123]
    ds_read_b64_tr_b16 v[176:177], v13 offset:43104
    ds_read_b64_tr_b16 v[178:179], v13 offset:44640
    v_mfma_f32_32x32x16_bf16 v[124:139], v[156:159], a[24:27], v[124:139]
    ds_read_b64_tr_b16 v[180:181], v12 offset:43136
    ds_read_b64_tr_b16 v[182:183], v12 offset:44672
    buffer_load_dwordx4 a[92:95], v25, s[44:47], s27 offen offset:3072 sc1
    v_mfma_f32_32x32x16_bf16 v[140:155], v[160:163], a[24:27], v[140:155]
    ds_read_b64_tr_b16 v[184:185], v13 offset:43168
    ds_read_b64_tr_b16 v[186:187], v13 offset:44704
    s_waitcnt vmcnt(16) lgkmcnt(6)
    v_mfma_f32_32x32x16_bf16 v[60:75], v[164:167], a[28:31], v[60:75]
    ds_read_b64_tr_b16 v[156:157], v12 offset:49152
    ds_read_b64_tr_b16 v[158:159], v12 offset:50688
    v_mfma_f32_32x32x16_bf16 v[76:91], v[168:171], a[28:31], v[76:91]
    ds_read_b64_tr_b16 v[160:161], v13 offset:49184
    ds_read_b64_tr_b16 v[162:163], v13 offset:50720
    buffer_load_dwordx4 a[96:99], v25, s[44:47], s30 offen offset:0 sc1
    v_mfma_f32_32x32x16_bf16 v[92:107], v[172:175], a[28:31], v[92:107]
    ds_read_b64_tr_b16 v[164:165], v12 offset:49216
    ds_read_b64_tr_b16 v[166:167], v12 offset:50752
    s_waitcnt lgkmcnt(6)
    v_mfma_f32_32x32x16_bf16 v[108:123], v[176:179], a[28:31], v[108:123]
    ds_read_b64_tr_b16 v[168:169], v13 offset:49248
    ds_read_b64_tr_b16 v[170:171], v13 offset:50784
    buffer_load_dwordx4 a[100:103], v25, s[44:47], s30 offen offset:1024 sc1
    v_mfma_f32_32x32x16_bf16 v[124:139], v[180:183], a[28:31], v[124:139]
    ds_read_b64_tr_b16 v[172:173], v12 offset:49280
    ds_read_b64_tr_b16 v[174:175], v12 offset:50816
    v_mfma_f32_32x32x16_bf16 v[140:155], v[184:187], a[28:31], v[140:155]
    ds_read_b64_tr_b16 v[176:177], v13 offset:49312
    ds_read_b64_tr_b16 v[178:179], v13 offset:50848
    buffer_load_dwordx4 a[104:107], v25, s[44:47], s30 offen offset:2048 sc1
    s_waitcnt vmcnt(18) lgkmcnt(6)
    v_mfma_f32_32x32x16_bf16 v[60:75], v[156:159], a[32:35], v[60:75]
    ds_read_b64_tr_b16 v[180:181], v12 offset:55296
    ds_read_b64_tr_b16 v[182:183], v12 offset:56832
    v_mfma_f32_32x32x16_bf16 v[76:91], v[160:163], a[32:35], v[76:91]
    ds_read_b64_tr_b16 v[184:185], v13 offset:55328
    ds_read_b64_tr_b16 v[186:187], v13 offset:56864
    v_mfma_f32_32x32x16_bf16 v[92:107], v[164:167], a[32:35], v[92:107]
    ds_read_b64_tr_b16 v[156:157], v12 offset:55360
    ds_read_b64_tr_b16 v[158:159], v12 offset:56896
    buffer_load_dwordx4 a[108:111], v25, s[44:47], s30 offen offset:3072 sc1
    s_waitcnt lgkmcnt(6)
    v_mfma_f32_32x32x16_bf16 v[108:123], v[168:171], a[32:35], v[108:123]
    ds_read_b64_tr_b16 v[160:161], v13 offset:55392
    ds_read_b64_tr_b16 v[162:163], v13 offset:56928
    v_mfma_f32_32x32x16_bf16 v[124:139], v[172:175], a[32:35], v[124:139]
    ds_read_b64_tr_b16 v[164:165], v12 offset:55424
    ds_read_b64_tr_b16 v[166:167], v12 offset:56960
    buffer_load_dwordx4 a[112:115], v25, s[44:47], s31 offen offset:0 sc1
    v_mfma_f32_32x32x16_bf16 v[140:155], v[176:179], a[32:35], v[140:155]
    ds_read_b64_tr_b16 v[168:169], v13 offset:55456
    ds_read_b64_tr_b16 v[170:171], v13 offset:56992
    s_waitcnt vmcnt(19) lgkmcnt(6)
    v_mfma_f32_32x32x16_bf16 v[60:75], v[180:183], a[36:39], v[60:75]
    ds_read_b64_tr_b16 v[172:173], v14 offset:0
    ds_read_b64_tr_b16 v[174:175], v14 offset:1536
    v_mfma_f32_32x32x16_bf16 v[76:91], v[184:187], a[36:39], v[76:91]
    ds_read_b64_tr_b16 v[176:177], v15 offset:32
    ds_read_b64_tr_b16 v[178:179], v15 offset:1568
    buffer_load_dwordx4 a[116:119], v25, s[44:47], s31 offen offset:1024 sc1
    v_mfma_f32_32x32x16_bf16 v[92:107], v[156:159], a[36:39], v[92:107]
    ds_read_b64_tr_b16 v[180:181], v14 offset:64
    ds_read_b64_tr_b16 v[182:183], v14 offset:1600
    s_waitcnt lgkmcnt(6)
    v_mfma_f32_32x32x16_bf16 v[108:123], v[160:163], a[36:39], v[108:123]
    ds_read_b64_tr_b16 v[184:185], v15 offset:96
    ds_read_b64_tr_b16 v[186:187], v15 offset:1632
    buffer_load_dwordx4 a[120:123], v25, s[44:47], s31 offen offset:2048 sc1
    v_mfma_f32_32x32x16_bf16 v[124:139], v[164:167], a[36:39], v[124:139]
    ds_read_b64_tr_b16 v[156:157], v14 offset:128
    ds_read_b64_tr_b16 v[158:159], v14 offset:1664
    v_mfma_f32_32x32x16_bf16 v[140:155], v[168:171], a[36:39], v[140:155]
    ds_read_b64_tr_b16 v[160:161], v15 offset:160
    ds_read_b64_tr_b16 v[162:163], v15 offset:1696
    buffer_load_dwordx4 a[124:127], v25, s[44:47], s31 offen offset:3072 sc1
    s_waitcnt vmcnt(21) lgkmcnt(6)
    v_mfma_f32_32x32x16_bf16 v[60:75], v[172:175], a[40:43], v[60:75]
    ds_read_b64_tr_b16 v[164:165], v14 offset:6144
    ds_read_b64_tr_b16 v[166:167], v14 offset:7680
    v_mfma_f32_32x32x16_bf16 v[76:91], v[176:179], a[40:43], v[76:91]
    ds_read_b64_tr_b16 v[168:169], v15 offset:6176
    ds_read_b64_tr_b16 v[170:171], v15 offset:7712
    v_mfma_f32_32x32x16_bf16 v[92:107], v[180:183], a[40:43], v[92:107]
    ds_read_b64_tr_b16 v[172:173], v14 offset:6208
    ds_read_b64_tr_b16 v[174:175], v14 offset:7744
    s_add_u32 m0, s4, 135168
    s_mul_i32 s84, s27, 43
    s_add_u32 s84, s84, 88064
    buffer_load_dwordx4 v5, s[56:59], s84 offen offset:0 lds
    s_waitcnt lgkmcnt(6)
    v_mfma_f32_32x32x16_bf16 v[108:123], v[184:187], a[40:43], v[108:123]
    ds_read_b64_tr_b16 v[176:177], v15 offset:6240
    ds_read_b64_tr_b16 v[178:179], v15 offset:7776
    v_mfma_f32_32x32x16_bf16 v[124:139], v[156:159], a[40:43], v[124:139]
    ds_read_b64_tr_b16 v[180:181], v14 offset:6272
    ds_read_b64_tr_b16 v[182:183], v14 offset:7808
    v_mfma_f32_32x32x16_bf16 v[140:155], v[160:163], a[40:43], v[140:155]
    ds_read_b64_tr_b16 v[184:185], v15 offset:6304
    ds_read_b64_tr_b16 v[186:187], v15 offset:7840
    buffer_load_dwordx4 v6, s[56:59], s84 offen offset:1024 lds
    s_waitcnt vmcnt(22) lgkmcnt(6)
    v_mfma_f32_32x32x16_bf16 v[60:75], v[164:167], a[44:47], v[60:75]
    ds_read_b64_tr_b16 v[156:157], v14 offset:12288
    ds_read_b64_tr_b16 v[158:159], v14 offset:13824
    v_mfma_f32_32x32x16_bf16 v[76:91], v[168:171], a[44:47], v[76:91]
    ds_read_b64_tr_b16 v[160:161], v15 offset:12320
    ds_read_b64_tr_b16 v[162:163], v15 offset:13856
    v_mfma_f32_32x32x16_bf16 v[92:107], v[172:175], a[44:47], v[92:107]
    ds_read_b64_tr_b16 v[164:165], v14 offset:12352
    ds_read_b64_tr_b16 v[166:167], v14 offset:13888
    buffer_load_dwordx4 v7, s[56:59], s84 offen offset:2048 lds
    s_waitcnt lgkmcnt(6)
    v_mfma_f32_32x32x16_bf16 v[108:123], v[176:179], a[44:47], v[108:123]
    ds_read_b64_tr_b16 v[168:169], v15 offset:12384
    ds_read_b64_tr_b16 v[170:171], v15 offset:13920
    v_mfma_f32_32x32x16_bf16 v[124:139], v[180:183], a[44:47], v[124:139]
    ds_read_b64_tr_b16 v[172:173], v14 offset:12416
    ds_read_b64_tr_b16 v[174:175], v14 offset:13952
    v_mfma_f32_32x32x16_bf16 v[140:155], v[184:187], a[44:47], v[140:155]
    ds_read_b64_tr_b16 v[176:177], v15 offset:12448
    ds_read_b64_tr_b16 v[178:179], v15 offset:13984
    s_add_u32 m0, s4, 147456
    s_mul_i32 s84, s30, 43
    buffer_load_dwordx4 v5, s[56:59], s84 offen offset:0 lds
    s_waitcnt vmcnt(23) lgkmcnt(6)
    v_mfma_f32_32x32x16_bf16 v[60:75], v[156:159], a[48:51], v[60:75]
    ds_read_b64_tr_b16 v[180:181], v14 offset:18432
    ds_read_b64_tr_b16 v[182:183], v14 offset:19968
    v_mfma_f32_32x32x16_bf16 v[76:91], v[160:163], a[48:51], v[76:91]
    ds_read_b64_tr_b16 v[184:185], v15 offset:18464
    ds_read_b64_tr_b16 v[186:187], v15 offset:20000
    v_mfma_f32_32x32x16_bf16 v[92:107], v[164:167], a[48:51], v[92:107]
    ds_read_b64_tr_b16 v[156:157], v14 offset:18496
    ds_read_b64_tr_b16 v[158:159], v14 offset:20032
    buffer_load_dwordx4 v6, s[56:59], s84 offen offset:1024 lds
    s_waitcnt lgkmcnt(6)
    v_mfma_f32_32x32x16_bf16 v[108:123], v[168:171], a[48:51], v[108:123]
    ds_read_b64_tr_b16 v[160:161], v15 offset:18528
    ds_read_b64_tr_b16 v[162:163], v15 offset:20064
    v_mfma_f32_32x32x16_bf16 v[124:139], v[172:175], a[48:51], v[124:139]
    ds_read_b64_tr_b16 v[164:165], v14 offset:18560
    ds_read_b64_tr_b16 v[166:167], v14 offset:20096
    v_mfma_f32_32x32x16_bf16 v[140:155], v[176:179], a[48:51], v[140:155]
    ds_read_b64_tr_b16 v[168:169], v15 offset:18592
    ds_read_b64_tr_b16 v[170:171], v15 offset:20128
    s_waitcnt vmcnt(23) lgkmcnt(6)
    v_mfma_f32_32x32x16_bf16 v[60:75], v[180:183], a[52:55], v[60:75]
    ds_read_b64_tr_b16 v[172:173], v14 offset:24576
    ds_read_b64_tr_b16 v[174:175], v14 offset:26112
    buffer_load_dwordx4 v7, s[56:59], s84 offen offset:2048 lds
    v_mfma_f32_32x32x16_bf16 v[76:91], v[184:187], a[52:55], v[76:91]
    ds_read_b64_tr_b16 v[176:177], v15 offset:24608
    ds_read_b64_tr_b16 v[178:179], v15 offset:26144
    v_mfma_f32_32x32x16_bf16 v[92:107], v[156:159], a[52:55], v[92:107]
    ds_read_b64_tr_b16 v[180:181], v14 offset:24640
    ds_read_b64_tr_b16 v[182:183], v14 offset:26176
    s_waitcnt lgkmcnt(6)
    v_mfma_f32_32x32x16_bf16 v[108:123], v[160:163], a[52:55], v[108:123]
    ds_read_b64_tr_b16 v[184:185], v15 offset:24672
    ds_read_b64_tr_b16 v[186:187], v15 offset:26208
    buffer_load_dwordx2 v[216:217], v22, s[16:19], s79 offen offset:0 sc1
    v_mfma_f32_32x32x16_bf16 v[124:139], v[164:167], a[52:55], v[124:139]
    ds_read_b64_tr_b16 v[156:157], v14 offset:24704
    ds_read_b64_tr_b16 v[158:159], v14 offset:26240
    buffer_load_dwordx2 v[218:219], v22, s[16:19], s79 offen offset:512 sc1
    v_mfma_f32_32x32x16_bf16 v[140:155], v[168:171], a[52:55], v[140:155]
    ds_read_b64_tr_b16 v[160:161], v15 offset:24736
    ds_read_b64_tr_b16 v[162:163], v15 offset:26272
    buffer_load_dwordx2 v[220:221], v22, s[16:19], s79 offen offset:1024 sc1
    s_waitcnt vmcnt(26) lgkmcnt(6)
    v_mfma_f32_32x32x16_bf16 v[60:75], v[172:175], a[56:59], v[60:75]
    ds_read_b64_tr_b16 v[164:165], v14 offset:30720
    ds_read_b64_tr_b16 v[166:167], v14 offset:32256
    buffer_load_dwordx2 v[222:223], v22, s[16:19], s79 offen offset:1536 sc1
    v_mfma_f32_32x32x16_bf16 v[76:91], v[176:179], a[56:59], v[76:91]
    ds_read_b64_tr_b16 v[168:169], v15 offset:30752
    ds_read_b64_tr_b16 v[170:171], v15 offset:32288
    buffer_load_dwordx2 v[224:225], v22, s[16:19], s79 offen offset:2048 sc1
    v_mfma_f32_32x32x16_bf16 v[92:107], v[180:183], a[56:59], v[92:107]
    ds_read_b64_tr_b16 v[172:173], v14 offset:30784
    ds_read_b64_tr_b16 v[174:175], v14 offset:32320
    s_waitcnt lgkmcnt(6)
    v_mfma_f32_32x32x16_bf16 v[108:123], v[184:187], a[56:59], v[108:123]
    ds_read_b64_tr_b16 v[176:177], v15 offset:30816
    ds_read_b64_tr_b16 v[178:179], v15 offset:32352
    buffer_load_dwordx2 v[226:227], v22, s[16:19], s79 offen offset:2560 sc1
    v_mfma_f32_32x32x16_bf16 v[124:139], v[156:159], a[56:59], v[124:139]
    ds_read_b64_tr_b16 v[180:181], v14 offset:30848
    ds_read_b64_tr_b16 v[182:183], v14 offset:32384
    buffer_load_dwordx2 v[228:229], v22, s[16:19], s79 offen offset:3072 sc1
    v_mfma_f32_32x32x16_bf16 v[140:155], v[160:163], a[56:59], v[140:155]
    ds_read_b64_tr_b16 v[184:185], v15 offset:30880
    ds_read_b64_tr_b16 v[186:187], v15 offset:32416
    buffer_load_dwordx2 v[230:231], v22, s[16:19], s79 offen offset:3584 sc1
    s_barrier
    s_add_u32 m0, s5, 0
    s_add_u32 s85, s74, 0
    s_sub_u32 s84, s85, 1310720
    s_min_u32 s85, s85, s84
    s_waitcnt vmcnt(30) lgkmcnt(6)
    v_mfma_f32_32x32x16_bf16 v[60:75], v[164:167], a[60:63], v[60:75]
    ds_read_b64_tr_b16 v[156:157], v14 offset:36864
    ds_read_b64_tr_b16 v[158:159], v14 offset:38400
    buffer_load_dwordx4 v4, s[32:35], s85 offen lds
    v_mfma_f32_32x32x16_bf16 v[76:91], v[168:171], a[60:63], v[76:91]
    ds_read_b64_tr_b16 v[160:161], v15 offset:36896
    ds_read_b64_tr_b16 v[162:163], v15 offset:38432
    v_mfma_f32_32x32x16_bf16 v[92:107], v[172:175], a[60:63], v[92:107]
    ds_read_b64_tr_b16 v[164:165], v14 offset:36928
    ds_read_b64_tr_b16 v[166:167], v14 offset:38464
    s_add_u32 m0, s5, 4096
    s_waitcnt lgkmcnt(6)
    v_mfma_f32_32x32x16_bf16 v[108:123], v[176:179], a[60:63], v[108:123]
    ds_read_b64_tr_b16 v[168:169], v15 offset:36960
    ds_read_b64_tr_b16 v[170:171], v15 offset:38496
    buffer_load_dwordx4 v27, s[32:35], s85 offen lds
    v_mfma_f32_32x32x16_bf16 v[124:139], v[180:183], a[60:63], v[124:139]
    ds_read_b64_tr_b16 v[172:173], v14 offset:36992
    ds_read_b64_tr_b16 v[174:175], v14 offset:38528
    s_add_u32 m0, s5, 8192
    s_add_u32 s85, s85, 65536
    v_mfma_f32_32x32x16_bf16 v[140:155], v[184:187], a[60:63], v[140:155]
    ds_read_b64_tr_b16 v[176:177], v15 offset:37024
    ds_read_b64_tr_b16 v[178:179], v15 offset:38560
    buffer_load_dwordx4 v4, s[32:35], s85 offen lds
    s_waitcnt vmcnt(32) lgkmcnt(6)
    v_mfma_f32_32x32x16_bf16 v[60:75], v[156:159], a[64:67], v[60:75]
    ds_read_b64_tr_b16 v[180:181], v14 offset:43008
    ds_read_b64_tr_b16 v[182:183], v14 offset:44544
    v_mfma_f32_32x32x16_bf16 v[76:91], v[160:163], a[64:67], v[76:91]
    ds_read_b64_tr_b16 v[184:185], v15 offset:43040
    ds_read_b64_tr_b16 v[186:187], v15 offset:44576
    s_add_u32 m0, s5, 12288
    v_mfma_f32_32x32x16_bf16 v[92:107], v[164:167], a[64:67], v[92:107]
    ds_read_b64_tr_b16 v[156:157], v14 offset:43072
    ds_read_b64_tr_b16 v[158:159], v14 offset:44608
    buffer_load_dwordx4 v27, s[32:35], s85 offen lds
    s_waitcnt lgkmcnt(6)
    v_mfma_f32_32x32x16_bf16 v[108:123], v[168:171], a[64:67], v[108:123]
    ds_read_b64_tr_b16 v[160:161], v15 offset:43104
    ds_read_b64_tr_b16 v[162:163], v15 offset:44640
    v_mfma_f32_32x32x16_bf16 v[124:139], v[172:175], a[64:67], v[124:139]
    ds_read_b64_tr_b16 v[164:165], v14 offset:43136
    ds_read_b64_tr_b16 v[166:167], v14 offset:44672
    s_add_u32 m0, s5, 16384
    s_add_u32 s85, s74, 131072
    s_sub_u32 s84, s85, 1310720
    s_min_u32 s85, s85, s84
    v_mfma_f32_32x32x16_bf16 v[140:155], v[176:179], a[64:67], v[140:155]
    ds_read_b64_tr_b16 v[168:169], v15 offset:43168
    ds_read_b64_tr_b16 v[170:171], v15 offset:44704
    buffer_load_dwordx4 v4, s[32:35], s85 offen lds
    s_waitcnt vmcnt(33) lgkmcnt(6)
    v_mfma_f32_32x32x16_bf16 v[60:75], v[180:183], a[68:71], v[60:75]
    ds_read_b64_tr_b16 v[172:173], v14 offset:49152
    ds_read_b64_tr_b16 v[174:175], v14 offset:50688
    s_add_u32 m0, s5, 20480
    v_mfma_f32_32x32x16_bf16 v[76:91], v[184:187], a[68:71], v[76:91]
    ds_read_b64_tr_b16 v[176:177], v15 offset:49184
    ds_read_b64_tr_b16 v[178:179], v15 offset:50720
    buffer_load_dwordx4 v27, s[32:35], s85 offen lds
    v_mfma_f32_32x32x16_bf16 v[92:107], v[156:159], a[68:71], v[92:107]
    ds_read_b64_tr_b16 v[180:181], v14 offset:49216
    ds_read_b64_tr_b16 v[182:183], v14 offset:50752
    s_waitcnt lgkmcnt(6)
    v_mfma_f32_32x32x16_bf16 v[108:123], v[160:163], a[68:71], v[108:123]
    ds_read_b64_tr_b16 v[184:185], v15 offset:49248
    ds_read_b64_tr_b16 v[186:187], v15 offset:50784
    v_mfma_f32_32x32x16_bf16 v[124:139], v[164:167], a[68:71], v[124:139]
    ds_read_b64_tr_b16 v[156:157], v14 offset:49280
    ds_read_b64_tr_b16 v[158:159], v14 offset:50816
    buffer_load_dwordx4 v[188:191], v23, s[52:55], s81 offen offset:0 sc1
    v_mfma_f32_32x32x16_bf16 v[140:155], v[168:171], a[68:71], v[140:155]
    ds_read_b64_tr_b16 v[160:161], v15 offset:49312
    ds_read_b64_tr_b16 v[162:163], v15 offset:50848
    buffer_load_dwordx4 v[192:195], v23, s[52:55], s81 offen offset:512 sc1
    s_waitcnt vmcnt(35) lgkmcnt(6)
    v_mfma_f32_32x32x16_bf16 v[60:75], v[172:175], a[72:75], v[60:75]
    ds_read_b64_tr_b16 v[164:165], v14 offset:55296
    ds_read_b64_tr_b16 v[166:167], v14 offset:56832
    buffer_load_dwordx4 v[196:199], v23, s[52:55], s81 offen offset:1024 sc1
    v_mfma_f32_32x32x16_bf16 v[76:91], v[176:179], a[72:75], v[76:91]
    ds_read_b64_tr_b16 v[168:169], v15 offset:55328
    ds_read_b64_tr_b16 v[170:171], v15 offset:56864
    buffer_load_dwordx4 v[200:203], v23, s[52:55], s81 offen offset:1536 sc1
    v_mfma_f32_32x32x16_bf16 v[92:107], v[180:183], a[72:75], v[92:107]
    ds_read_b64_tr_b16 v[172:173], v14 offset:55360
    ds_read_b64_tr_b16 v[174:175], v14 offset:56896
    s_waitcnt lgkmcnt(6)
    v_mfma_f32_32x32x16_bf16 v[108:123], v[184:187], a[72:75], v[108:123]
    ds_read_b64_tr_b16 v[176:177], v15 offset:55392
    ds_read_b64_tr_b16 v[178:179], v15 offset:56928
    buffer_load_dwordx4 v[204:207], v23, s[52:55], s81 offen offset:2048 sc1
    v_mfma_f32_32x32x16_bf16 v[124:139], v[156:159], a[72:75], v[124:139]
    ds_read_b64_tr_b16 v[180:181], v14 offset:55424
    ds_read_b64_tr_b16 v[182:183], v14 offset:56960
    buffer_load_dwordx4 v[208:211], v23, s[52:55], s81 offen offset:2560 sc1
    s_add_u32 m0, s5, 24576
    s_add_u32 s85, s85, 65536
    v_mfma_f32_32x32x16_bf16 v[140:155], v[160:163], a[72:75], v[140:155]
L_page_5:
    s_cbranch_execz L_page_7
    ds_read_b64_tr_b16 v[184:185], v15 offset:55456
    ds_read_b64_tr_b16 v[186:187], v15 offset:56992
    buffer_load_dwordx4 v4, s[32:35], s85 offen lds
    s_waitcnt vmcnt(39) lgkmcnt(6)
    v_mfma_f32_32x32x16_bf16 v[60:75], v[164:167], a[76:79], v[60:75]
    ds_read_b64_tr_b16 v[156:157], v16 offset:0
    ds_read_b64_tr_b16 v[158:159], v16 offset:1536
    s_waitcnt vmcnt(16)
    v_add_f32 v216, v216, v224
    v_add_f32 v217, v217, v225
    s_waitcnt vmcnt(15)
    v_add_f32 v218, v218, v226
    v_mfma_f32_32x32x16_bf16 v[76:91], v[168:171], a[76:79], v[76:91]
    ds_read_b64_tr_b16 v[160:161], v17 offset:32
    ds_read_b64_tr_b16 v[162:163], v17 offset:1568
    s_add_u32 m0, s5, 28672
    v_add_f32 v219, v219, v227
    v_mfma_f32_32x32x16_bf16 v[92:107], v[172:175], a[76:79], v[92:107]
    ds_read_b64_tr_b16 v[164:165], v16 offset:64
    ds_read_b64_tr_b16 v[166:167], v16 offset:1600
    buffer_load_dwordx4 v27, s[32:35], s85 offen lds
    s_waitcnt vmcnt(15)
    v_add_f32 v220, v220, v228
    v_add_f32 v221, v221, v229
    s_waitcnt lgkmcnt(6)
    v_mfma_f32_32x32x16_bf16 v[108:123], v[176:179], a[76:79], v[108:123]
    ds_read_b64_tr_b16 v[168:169], v17 offset:96
    ds_read_b64_tr_b16 v[170:171], v17 offset:1632
    s_add_u32 m0, s5, 32768
    s_add_u32 s85, s74, 262144
    s_sub_u32 s84, s85, 1310720
    s_min_u32 s85, s85, s84
    v_mfma_f32_32x32x16_bf16 v[124:139], v[180:183], a[76:79], v[124:139]
    ds_read_b64_tr_b16 v[172:173], v16 offset:128
    ds_read_b64_tr_b16 v[174:175], v16 offset:1664
    buffer_load_dwordx4 v4, s[32:35], s85 offen lds
    v_mfma_f32_32x32x16_bf16 v[140:155], v[184:187], a[76:79], v[140:155]
    ds_read_b64_tr_b16 v[176:177], v17 offset:160
    ds_read_b64_tr_b16 v[178:179], v17 offset:1696
    s_barrier
    s_waitcnt vmcnt(15)
    v_add_f32 v222, v222, v230
    v_add_f32 v223, v223, v231
    s_waitcnt lgkmcnt(6)
    v_mfma_f32_32x32x16_bf16 v[60:75], v[156:159], a[80:83], v[60:75]
    ds_read_b64_tr_b16 v[180:181], v16 offset:6144
    ds_read_b64_tr_b16 v[182:183], v16 offset:7680
    s_add_u32 m0, s5, 36864
    v_add_f32 v216, v216, v220
    v_add_f32 v217, v217, v221
    v_mfma_f32_32x32x16_bf16 v[76:91], v[160:163], a[80:83], v[76:91]
    ds_read_b64_tr_b16 v[184:185], v16 offset:12288
    ds_read_b64_tr_b16 v[186:187], v16 offset:13824
    buffer_load_dwordx4 v27, s[32:35], s85 offen lds
    v_add_f32 v218, v218, v222
    v_mfma_f32_32x32x16_bf16 v[92:107], v[164:167], a[80:83], v[92:107]
    ds_read_b64_tr_b16 v[156:157], v16 offset:18432
    ds_read_b64_tr_b16 v[158:159], v16 offset:19968
    s_add_u32 m0, s5, 40960
    s_add_u32 s85, s85, 65536
    v_add_f32 v219, v219, v223
    s_waitcnt lgkmcnt(6)
    v_mfma_f32_32x32x16_bf16 v[108:123], v[168:171], a[80:83], v[108:123]
    ds_read_b64_tr_b16 v[160:161], v16 offset:24576
    ds_read_b64_tr_b16 v[162:163], v16 offset:26112
    buffer_load_dwordx4 v4, s[32:35], s85 offen lds
    v_add_f32 v216, v216, v218
    v_add_f32 v217, v217, v219
    v_mfma_f32_32x32x16_bf16 v[124:139], v[172:175], a[80:83], v[124:139]
    ds_read_b64_tr_b16 v[164:165], v16 offset:30720
    ds_read_b64_tr_b16 v[166:167], v16 offset:32256
    v_mov_b32 v218, v216
    v_mov_b32 v219, v217
    v_mov_b32 v215, 0
    v_mfma_f32_32x32x16_bf16 v[140:155], v[176:179], a[80:83], v[140:155]
    ds_read_b64_tr_b16 v[168:169], v17 offset:6176
    ds_read_b64_tr_b16 v[170:171], v17 offset:7712
    s_add_u32 m0, s5, 45056
    v_permlane32_swap_b32 v216, v218
    s_waitcnt lgkmcnt(6)
    v_mfma_f32_32x32x16_bf16 v[60:75], v[180:183], a[84:87], v[60:75]
    ds_read_b64_tr_b16 v[172:173], v17 offset:12320
    ds_read_b64_tr_b16 v[174:175], v17 offset:13856
    buffer_load_dwordx4 v27, s[32:35], s85 offen lds
    v_permlane32_swap_b32 v217, v219
    v_add_f32 v216, v216, v218
    v_mfma_f32_32x32x16_bf16 v[60:75], v[184:187], a[88:91], v[60:75]
    ds_read_b64_tr_b16 v[176:177], v17 offset:18464
    ds_read_b64_tr_b16 v[178:179], v17 offset:20000
    v_add_f32 v217, v217, v219
    v_mul_f32 v216, 0xbb000000, v216
    v_mul_f32 v217, 0x3b000000, v217
    v_mfma_f32_32x32x16_bf16 v[60:75], v[156:159], a[92:95], v[60:75]
    ds_read_b64_tr_b16 v[180:181], v17 offset:24608
    ds_read_b64_tr_b16 v[182:183], v17 offset:26144
    s_add_u32 m0, s5, 49152
    s_add_u32 s85, s74, 393216
    s_sub_u32 s84, s85, 1310720
    s_min_u32 s85, s85, s84
    s_waitcnt lgkmcnt(6)
    v_mfma_f32_32x32x16_bf16 v[60:75], v[160:163], a[96:99], v[60:75]
    ds_read_b64_tr_b16 v[184:185], v17 offset:30752
    ds_read_b64_tr_b16 v[186:187], v17 offset:32288
    buffer_load_dwordx4 v4, s[32:35], s85 offen lds
    v_mfma_f32_32x32x16_bf16 v[60:75], v[164:167], a[100:103], v[60:75]
    ds_read_b64_tr_b16 v[156:157], v16 offset:6208
    ds_read_b64_tr_b16 v[158:159], v16 offset:7744
    s_add_u32 m0, s5, 53248
    v_cmp_gt_u32 vcc, 32, v1
    v_fma_f32 v217, -v216, v216, v217
    v_mfma_f32_32x32x16_bf16 v[60:75], a[128:131], a[104:107], v[60:75]
    buffer_load_dwordx4 v27, s[32:35], s85 offen lds
    v_max_f32 v217, 0, v217
    v_add_f32 v232, 0x3727c5ac, v217
    v_rsq_f32 v218, v232
    v_mfma_f32_32x32x16_bf16 v[60:75], a[152:155], a[108:111], v[60:75]
    v_cndmask_b32 v216, 0, v216, vcc
    v_mul_f32 v217, v232, v218
    v_mul_f32 v234, 0xc0135761, v218
    v_mul_f32 v218, v218, v218
    v_mfma_f32_32x32x16_bf16 v[60:75], a[176:179], a[112:115], v[60:75]
    s_add_u32 m0, s5, 57344
    s_add_u32 s85, s85, 65536
    v_cndmask_b32 v217, 0, v217, vcc
    v_mul_f32 v218, 0x3d372713, v218
    v_mul_f32 v236, v234, v218
    v_mfma_f32_32x32x16_bf16 v[60:75], a[200:203], a[116:119], v[60:75]
    buffer_load_dwordx4 v4, s[32:35], s85 offen lds
    v_cvt_pk_bf16_f32 v218, 0, v216
    v_cvt_pk_bf16_f32 v219, 0, v217
    v_sub_f32 v218, v216, v218
    v_mfma_f32_32x32x16_bf16 v[60:75], a[224:227], a[120:123], v[60:75]
    s_add_u32 m0, s5, 61440
    v_sub_f32 v219, v217, v219
    v_cvt_pk_bf16_f32 v212, v216, v216
    v_cvt_pk_bf16_f32 v213, v218, v217
    v_cvt_pk_bf16_f32 v214, v217, v219
    v_mfma_f32_32x32x16_bf16 v[60:75], a[248:251], a[124:127], v[60:75]
    buffer_load_dwordx4 v27, s[32:35], s85 offen lds
    s_waitcnt vmcnt(15)
    v_xor_b32 v191, s82, v191
    s_waitcnt vmcnt(14)
    v_xor_b32 v195, s82, v195
    s_waitcnt vmcnt(13)
    v_xor_b32 v199, s82, v199
    s_waitcnt vmcnt(12)
    v_xor_b32 v203, s82, v203
    s_waitcnt vmcnt(11)
    v_xor_b32 v207, s82, v207
    s_waitcnt vmcnt(10)
    v_xor_b32 v211, s82, v211
    v_or3_b32 v216, v191, v195, v199
    v_or3_b32 v217, v203, v207, v211
    v_or_b32 v216, v216, v217
    v_cmp_ne_u32 vcc, 0, v216
    s_cbranch_vccz L_rtok_55
    s_mov_b32 s67, 0
L_rt_54:
    buffer_load_dwordx4 v[188:191], v23, s[52:55], s81 offen offset:0 sc1
    buffer_load_dwordx4 v[192:195], v23, s[52:55], s81 offen offset:512 sc1
    buffer_load_dwordx4 v[196:199], v23, s[52:55], s81 offen offset:1024 sc1
    buffer_load_dwordx4 v[200:203], v23, s[52:55], s81 offen offset:1536 sc1
    buffer_load_dwordx4 v[204:207], v23, s[52:55], s81 offen offset:2048 sc1
    buffer_load_dwordx4 v[208:211], v23, s[52:55], s81 offen offset:2560 sc1
    s_add_u32 s67, s67, 1
    s_waitcnt vmcnt(0)
    v_xor_b32 v191, s82, v191
    v_xor_b32 v195, s82, v195
    v_xor_b32 v199, s82, v199
    v_xor_b32 v203, s82, v203
    v_xor_b32 v207, s82, v207
    v_xor_b32 v211, s82, v211
    v_or3_b32 v216, v191, v195, v199
    v_or3_b32 v217, v203, v207, v211
    v_or_b32 v216, v216, v217
    v_cmp_ne_u32 vcc, 0, v216
    s_cbranch_vccz L_rtok_55
    s_cmp_lt_u32 s67, 20000
    s_cbranch_scc1 L_rt_54
L_rtok_55:
    v_mfma_f32_32x32x16_bf16 v[60:75], v[188:191], v[212:215], v[60:75]
    v_mfma_f32_32x32x16_bf16 v[76:91], v[168:171], a[84:87], v[76:91]
    ds_read_b64_tr_b16 v[160:161], v16 offset:12352
    ds_read_b64_tr_b16 v[162:163], v16 offset:13888
    s_add_u32 m0, s5, 65536
    s_add_u32 s85, s74, 524288
    s_sub_u32 s84, s85, 1310720
    s_min_u32 s85, s85, s84
    s_waitcnt lgkmcnt(6)
    v_mfma_f32_32x32x16_bf16 v[76:91], v[172:175], a[88:91], v[76:91]
    ds_read_b64_tr_b16 v[164:165], v16 offset:18496
    ds_read_b64_tr_b16 v[166:167], v16 offset:20032
    buffer_load_dwordx4 v4, s[32:35], s85 offen lds
    v_mul_f32 v216, v60, v60
    v_mul_f32 v217, v61, v61
    v_mul_f32 v218, v62, v62
    v_mul_f32 v219, v63, v63
    v_fma_f32 v216, v216, v236, v234
    v_fma_f32 v217, v217, v236, v234
    v_mfma_f32_32x32x16_bf16 v[76:91], v[176:179], a[92:95], v[76:91]
    ds_read_b64_tr_b16 v[168:169], v16 offset:24640
    ds_read_b64_tr_b16 v[170:171], v16 offset:26176
    v_fma_f32 v218, v218, v236, v234
    v_fma_f32 v219, v219, v236, v234
    v_mul_f32 v216, v216, v60
    v_mul_f32 v217, v217, v61
    v_mul_f32 v218, v218, v62
    v_mul_f32 v219, v219, v63
    v_exp_f32 v216, v216
    v_mfma_f32_32x32x16_bf16 v[76:91], v[180:183], a[96:99], v[76:91]
    ds_read_b64_tr_b16 v[172:173], v16 offset:30784
    ds_read_b64_tr_b16 v[174:175], v16 offset:32320
    s_add_u32 m0, s5, 69632
    v_mul_f32 v60, v60, v64
    v_exp_f32 v217, v217
    v_mul_f32 v61, v61, v65
    v_exp_f32 v218, v218
    s_waitcnt lgkmcnt(6)
    v_mfma_f32_32x32x16_bf16 v[76:91], v[184:187], a[100:103], v[76:91]
    ds_read_b64_tr_b16 v[176:177], v17 offset:6240
    ds_read_b64_tr_b16 v[178:179], v17 offset:7776
    buffer_load_dwordx4 v27, s[32:35], s85 offen lds
    v_mul_f32 v62, v62, v66
    v_exp_f32 v219, v219
    v_mul_f32 v63, v63, v67
    v_fma_f32 v216, v216, v232, v232
    v_mfma_f32_32x32x16_bf16 v[76:91], a[132:135], a[104:107], v[76:91]
    s_add_u32 m0, s5, 73728
    s_add_u32 s85, s85, 65536
    v_rcp_f32 v216, v216
    v_fma_f32 v217, v217, v232, v232
    v_rcp_f32 v217, v217
    v_fma_f32 v218, v218, v232, v232
    v_rcp_f32 v218, v218
    v_mfma_f32_32x32x16_bf16 v[76:91], a[156:159], a[108:111], v[76:91]
    buffer_load_dwordx4 v4, s[32:35], s85 offen lds
    v_fma_f32 v219, v219, v232, v232
    v_rcp_f32 v219, v219
    v_mul_f32 v60, v60, v216
    v_mul_f32 v61, v61, v217
    v_mul_f32 v62, v62, v218
    v_mul_f32 v63, v63, v219
    v_mfma_f32_32x32x16_bf16 v[76:91], a[180:183], a[112:115], v[76:91]
    v_cvt_pk_bf16_f32 v240, v60, v61
    v_cvt_pk_bf16_f32 v241, v62, v63
    v_mul_f32 v220, v68, v68
    v_mul_f32 v221, v69, v69
    v_mul_f32 v222, v70, v70
    v_mul_f32 v223, v71, v71
    v_fma_f32 v220, v220, v236, v234
    v_fma_f32 v221, v221, v236, v234
    v_fma_f32 v222, v222, v236, v234
    v_mfma_f32_32x32x16_bf16 v[76:91], a[204:207], a[116:119], v[76:91]
    s_add_u32 m0, s5, 77824
    v_fma_f32 v223, v223, v236, v234
    v_mul_f32 v220, v220, v68
    v_mul_f32 v221, v221, v69
    v_mul_f32 v222, v222, v70
    v_mul_f32 v223, v223, v71
    v_exp_f32 v220, v220
    v_mul_f32 v68, v68, v72
    v_mfma_f32_32x32x16_bf16 v[76:91], a[228:231], a[120:123], v[76:91]
    buffer_load_dwordx4 v27, s[32:35], s85 offen lds
    v_exp_f32 v221, v221
    v_mul_f32 v69, v69, v73
    v_exp_f32 v222, v222
    v_mul_f32 v70, v70, v74
    v_exp_f32 v223, v223
    v_mfma_f32_32x32x16_bf16 v[76:91], a[252:255], a[124:127], v[76:91]
    s_add_u32 m0, s5, 81920
    s_add_u32 s85, s74, 655360
    s_sub_u32 s84, s85, 1310720
    s_min_u32 s85, s85, s84
    v_mul_f32 v71, v71, v75
    v_fma_f32 v220, v220, v232, v232
    v_rcp_f32 v220, v220
    v_fma_f32 v221, v221, v232, v232
    v_mfma_f32_32x32x16_bf16 v[76:91], v[192:195], v[212:215], v[76:91]
    buffer_load_dwordx4 v4, s[32:35], s85 offen lds
    v_rcp_f32 v221, v221
    v_fma_f32 v222, v222, v232, v232
    v_rcp_f32 v222, v222
    v_fma_f32 v223, v223, v232, v232
    v_rcp_f32 v223, v223
    v_mfma_f32_32x32x16_bf16 v[92:107], v[156:159], a[84:87], v[92:107]
    ds_read_b64_tr_b16 v[180:181], v17 offset:12384
    ds_read_b64_tr_b16 v[182:183], v17 offset:13920
    v_mul_f32 v68, v68, v220
    v_mul_f32 v69, v69, v221
    v_mul_f32 v70, v70, v222
    v_mul_f32 v71, v71, v223
    v_cvt_pk_bf16_f32 v242, v68, v69
    v_cvt_pk_bf16_f32 v243, v70, v71
    buffer_store_dwordx4 v[240:243], v2, s[16:19], s80 offen offset:0 sc1
    v_mfma_f32_32x32x16_bf16 v[92:107], v[160:163], a[88:91], v[92:107]
    ds_read_b64_tr_b16 v[184:185], v17 offset:18528
    ds_read_b64_tr_b16 v[186:187], v17 offset:20064
    s_add_u32 m0, s5, 86016
    v_mul_f32 v216, v76, v76
    v_mul_f32 v217, v77, v77
    v_mul_f32 v218, v78, v78
    v_mul_f32 v219, v79, v79
    v_fma_f32 v216, v216, v236, v234
    v_fma_f32 v217, v217, v236, v234
    s_waitcnt lgkmcnt(6)
    v_mfma_f32_32x32x16_bf16 v[92:107], v[164:167], a[92:95], v[92:107]
    ds_read_b64_tr_b16 v[156:157], v17 offset:24672
    ds_read_b64_tr_b16 v[158:159], v17 offset:26208
    buffer_load_dwordx4 v27, s[32:35], s85 offen lds
    v_fma_f32 v218, v218, v236, v234
    v_fma_f32 v219, v219, v236, v234
    v_mul_f32 v216, v216, v76
    v_mul_f32 v217, v217, v77
    v_mul_f32 v218, v218, v78
    v_mul_f32 v219, v219, v79
    v_mfma_f32_32x32x16_bf16 v[92:107], v[168:171], a[96:99], v[92:107]
    ds_read_b64_tr_b16 v[160:161], v17 offset:30816
    ds_read_b64_tr_b16 v[162:163], v17 offset:32352
    v_exp_f32 v216, v216
    v_mul_f32 v76, v76, v80
    v_exp_f32 v217, v217
    v_mul_f32 v77, v77, v81
    v_exp_f32 v218, v218
    v_mfma_f32_32x32x16_bf16 v[92:107], v[172:175], a[100:103], v[92:107]
    ds_read_b64_tr_b16 v[164:165], v16 offset:6272
    ds_read_b64_tr_b16 v[166:167], v16 offset:7808
    s_add_u32 m0, s5, 90112
    s_add_u32 s85, s74, 720896
    s_sub_u32 s84, s85, 1310720
    s_min_u32 s85, s85, s84
    v_mul_f32 v78, v78, v82
    v_exp_f32 v219, v219
    v_mfma_f32_32x32x16_bf16 v[92:107], a[136:139], a[104:107], v[92:107]
    buffer_load_dwordx4 v4, s[32:35], s85 offen lds
    v_mul_f32 v79, v79, v83
    v_fma_f32 v216, v216, v232, v232
    v_rcp_f32 v216, v216
    v_fma_f32 v217, v217, v232, v232
    v_rcp_f32 v217, v217
    v_fma_f32 v218, v218, v232, v232
    v_mfma_f32_32x32x16_bf16 v[92:107], a[160:163], a[108:111], v[92:107]
    s_add_u32 m0, s5, 94208
    v_rcp_f32 v218, v218
    v_fma_f32 v219, v219, v232, v232
    v_rcp_f32 v219, v219
    v_mul_f32 v76, v76, v216
    v_mul_f32 v77, v77, v217
    v_mul_f32 v78, v78, v218
    v_mul_f32 v79, v79, v219
    v_mfma_f32_32x32x16_bf16 v[92:107], a[184:187], a[112:115], v[92:107]
    buffer_load_dwordx4 v27, s[32:35], s85 offen lds
    v_cvt_pk_bf16_f32 v244, v76, v77
    v_cvt_pk_bf16_f32 v245, v78, v79
    v_mul_f32 v220, v84, v84
    v_mul_f32 v221, v85, v85
    v_mul_f32 v222, v86, v86
    v_mul_f32 v223, v87, v87
    v_fma_f32 v220, v220, v236, v234
    v_fma_f32 v221, v221, v236, v234
    v_mfma_f32_32x32x16_bf16 v[92:107], a[208:211], a[116:119], v[92:107]
    v_fma_f32 v222, v222, v236, v234
    v_fma_f32 v223, v223, v236, v234
    v_mul_f32 v220, v220, v84
    v_mul_f32 v221, v221, v85
    v_mul_f32 v222, v222, v86
    v_mul_f32 v223, v223, v87
    v_exp_f32 v220, v220
    v_mul_f32 v84, v84, v88
    v_mfma_f32_32x32x16_bf16 v[92:107], a[232:235], a[120:123], v[92:107]
    s_add_u32 m0, s5, 98304
    s_add_u32 s85, s74, 786432
    s_sub_u32 s84, s85, 1310720
    s_min_u32 s85, s85, s84
    v_exp_f32 v221, v221
    v_mul_f32 v85, v85, v89
    v_exp_f32 v222, v222
    v_mfma_f32_32x32x16_bf16 v[92:107], v[44:47], a[124:127], v[92:107]
    buffer_load_dwordx4 v4, s[32:35], s85 offen lds
    v_mul_f32 v86, v86, v90
    v_exp_f32 v223, v223
    v_mul_f32 v87, v87, v91
    v_fma_f32 v220, v220, v232, v232
    v_rcp_f32 v220, v220
    v_fma_f32 v221, v221, v232, v232
    v_mfma_f32_32x32x16_bf16 v[92:107], v[196:199], v[212:215], v[92:107]
    s_add_u32 m0, s5, 102400
    v_rcp_f32 v221, v221
    v_fma_f32 v222, v222, v232, v232
    v_rcp_f32 v222, v222
    v_fma_f32 v223, v223, v232, v232
    v_rcp_f32 v223, v223
    v_mul_f32 v84, v84, v220
    s_waitcnt lgkmcnt(6)
    v_mfma_f32_32x32x16_bf16 v[108:123], v[176:179], a[84:87], v[108:123]
    ds_read_b64_tr_b16 v[168:169], v16 offset:12416
    ds_read_b64_tr_b16 v[170:171], v16 offset:13952
    buffer_load_dwordx4 v27, s[32:35], s85 offen lds
    v_mul_f32 v85, v85, v221
    v_mul_f32 v86, v86, v222
    v_mul_f32 v87, v87, v223
    v_cvt_pk_bf16_f32 v246, v84, v85
    v_cvt_pk_bf16_f32 v247, v86, v87
    buffer_store_dwordx4 v[244:247], v2, s[16:19], s80 offen offset:1024 sc1
    v_mfma_f32_32x32x16_bf16 v[108:123], v[180:183], a[88:91], v[108:123]
    ds_read_b64_tr_b16 v[172:173], v16 offset:18560
    ds_read_b64_tr_b16 v[174:175], v16 offset:20096
    v_mul_f32 v216, v92, v92
    v_mul_f32 v217, v93, v93
    v_mul_f32 v218, v94, v94
    v_mul_f32 v219, v95, v95
    v_fma_f32 v216, v216, v236, v234
    v_fma_f32 v217, v217, v236, v234
    v_fma_f32 v218, v218, v236, v234
    v_mfma_f32_32x32x16_bf16 v[108:123], v[184:187], a[92:95], v[108:123]
    ds_read_b64_tr_b16 v[176:177], v16 offset:24704
    ds_read_b64_tr_b16 v[178:179], v16 offset:26240
    s_add_u32 m0, s5, 106496
    s_add_u32 s85, s85, 65536
    v_fma_f32 v219, v219, v236, v234
    v_mul_f32 v216, v216, v92
    v_mul_f32 v217, v217, v93
    v_mul_f32 v218, v218, v94
    v_mul_f32 v219, v219, v95
    s_waitcnt lgkmcnt(6)
    v_mfma_f32_32x32x16_bf16 v[108:123], v[156:159], a[96:99], v[108:123]
    ds_read_b64_tr_b16 v[180:181], v16 offset:30848
    ds_read_b64_tr_b16 v[182:183], v16 offset:32384
    buffer_load_dwordx4 v4, s[32:35], s85 offen lds
    v_exp_f32 v216, v216
    v_mul_f32 v92, v92, v96
    v_exp_f32 v217, v217
    v_mul_f32 v93, v93, v97
    v_mfma_f32_32x32x16_bf16 v[108:123], v[160:163], a[100:103], v[108:123]
    ds_read_b64_tr_b16 v[184:185], v17 offset:6304
    ds_read_b64_tr_b16 v[186:187], v17 offset:7840
    v_exp_f32 v218, v218
    v_mul_f32 v94, v94, v98
    v_exp_f32 v219, v219
    v_mul_f32 v95, v95, v99
    v_fma_f32 v216, v216, v232, v232
    v_mfma_f32_32x32x16_bf16 v[108:123], a[140:143], a[104:107], v[108:123]
    s_add_u32 m0, s5, 110592
    v_rcp_f32 v216, v216
    v_fma_f32 v217, v217, v232, v232
    v_rcp_f32 v217, v217
    v_fma_f32 v218, v218, v232, v232
    v_rcp_f32 v218, v218
    v_mfma_f32_32x32x16_bf16 v[108:123], a[164:167], a[108:111], v[108:123]
    buffer_load_dwordx4 v27, s[32:35], s85 offen lds
    v_fma_f32 v219, v219, v232, v232
    v_rcp_f32 v219, v219
    v_mul_f32 v92, v92, v216
    v_mul_f32 v93, v93, v217
    v_mul_f32 v94, v94, v218
    v_mul_f32 v95, v95, v219
    v_cvt_pk_bf16_f32 v240, v92, v93
    v_mfma_f32_32x32x16_bf16 v[108:123], a[188:191], a[112:115], v[108:123]
    s_add_u32 m0, s5, 114688
    s_add_u32 s85, s74, 917504
    s_sub_u32 s84, s85, 1310720
    s_min_u32 s85, s85, s84
    v_cvt_pk_bf16_f32 v241, v94, v95
    v_mul_f32 v220, v100, v100
    v_mul_f32 v221, v101, v101
    v_mul_f32 v222, v102, v102
    v_mfma_f32_32x32x16_bf16 v[108:123], a[212:215], a[116:119], v[108:123]
    buffer_load_dwordx4 v4, s[32:35], s85 offen lds
    v_mul_f32 v223, v103, v103
    v_fma_f32 v220, v220, v236, v234
    v_fma_f32 v221, v221, v236, v234
    v_fma_f32 v222, v222, v236, v234
    v_fma_f32 v223, v223, v236, v234
    v_mul_f32 v220, v220, v100
    v_mul_f32 v221, v221, v101
    v_mul_f32 v222, v222, v102
    v_mfma_f32_32x32x16_bf16 v[108:123], a[236:239], a[120:123], v[108:123]
    v_mul_f32 v223, v223, v103
    v_exp_f32 v220, v220
    v_mul_f32 v100, v100, v104
    v_exp_f32 v221, v221
    v_mul_f32 v101, v101, v105
    v_exp_f32 v222, v222
    v_mfma_f32_32x32x16_bf16 v[108:123], v[48:51], a[124:127], v[108:123]
    s_add_u32 m0, s5, 118784
    v_mul_f32 v102, v102, v106
    v_exp_f32 v223, v223
    v_mul_f32 v103, v103, v107
    v_fma_f32 v220, v220, v232, v232
    v_rcp_f32 v220, v220
    v_fma_f32 v221, v221, v232, v232
    v_mfma_f32_32x32x16_bf16 v[108:123], v[200:203], v[212:215], v[108:123]
    buffer_load_dwordx4 v27, s[32:35], s85 offen lds
    v_rcp_f32 v221, v221
    v_fma_f32 v222, v222, v232, v232
    v_rcp_f32 v222, v222
    v_fma_f32 v223, v223, v232, v232
    v_rcp_f32 v223, v223
    v_mfma_f32_32x32x16_bf16 v[124:139], v[164:167], a[84:87], v[124:139]
    ds_read_b64_tr_b16 v[156:157], v17 offset:12448
    ds_read_b64_tr_b16 v[158:159], v17 offset:13984
    v_mul_f32 v100, v100, v220
    v_mul_f32 v101, v101, v221
    v_mul_f32 v102, v102, v222
    v_mul_f32 v103, v103, v223
    v_cvt_pk_bf16_f32 v242, v100, v101
    v_cvt_pk_bf16_f32 v243, v102, v103
    buffer_store_dwordx4 v[240:243], v2, s[12:15], s66 offen offset:0 sc1
    s_waitcnt lgkmcnt(6)
    v_mfma_f32_32x32x16_bf16 v[124:139], v[168:171], a[88:91], v[124:139]
    ds_read_b64_tr_b16 v[160:161], v17 offset:18592
    ds_read_b64_tr_b16 v[162:163], v17 offset:20128
    v_mul_f32 v216, v108, v108
    v_mul_f32 v217, v109, v109
    v_mul_f32 v218, v110, v110
    v_mul_f32 v219, v111, v111
    v_fma_f32 v216, v216, v236, v234
    v_fma_f32 v217, v217, v236, v234
    v_fma_f32 v218, v218, v236, v234
    v_mfma_f32_32x32x16_bf16 v[124:139], v[172:175], a[92:95], v[124:139]
    ds_read_b64_tr_b16 v[164:165], v17 offset:24736
    ds_read_b64_tr_b16 v[166:167], v17 offset:26272
    v_fma_f32 v219, v219, v236, v234
    v_mul_f32 v216, v216, v108
    v_mul_f32 v217, v217, v109
    v_mul_f32 v218, v218, v110
    v_mul_f32 v219, v219, v111
    v_exp_f32 v216, v216
    v_mfma_f32_32x32x16_bf16 v[124:139], v[176:179], a[96:99], v[124:139]
    ds_read_b64_tr_b16 v[168:169], v17 offset:30880
    ds_read_b64_tr_b16 v[170:171], v17 offset:32416
    v_mul_f32 v108, v108, v112
    v_exp_f32 v217, v217
    v_mul_f32 v109, v109, v113
    v_exp_f32 v218, v218
    s_waitcnt lgkmcnt(6)
    v_mfma_f32_32x32x16_bf16 v[124:139], v[180:183], a[100:103], v[124:139]
    v_mul_f32 v110, v110, v114
    v_exp_f32 v219, v219
    v_mul_f32 v111, v111, v115
    v_fma_f32 v216, v216, v232, v232
    v_rcp_f32 v216, v216
    v_fma_f32 v217, v217, v232, v232
    v_mfma_f32_32x32x16_bf16 v[124:139], a[144:147], a[104:107], v[124:139]
    v_rcp_f32 v217, v217
    v_fma_f32 v218, v218, v232, v232
    v_rcp_f32 v218, v218
    v_fma_f32 v219, v219, v232, v232
    v_rcp_f32 v219, v219
    v_mul_f32 v108, v108, v216
    v_mfma_f32_32x32x16_bf16 v[124:139], a[168:171], a[108:111], v[124:139]
    s_waitcnt vmcnt(23)
    s_waitcnt lgkmcnt(0)
    s_barrier
    v_mul_f32 v109, v109, v217
    v_mul_f32 v110, v110, v218
    v_mul_f32 v111, v111, v219
    v_cvt_pk_bf16_f32 v244, v108, v109
    v_cvt_pk_bf16_f32 v245, v110, v111
    v_mul_f32 v220, v116, v116
    v_mul_f32 v221, v117, v117
    v_mfma_f32_32x32x16_bf16 v[124:139], a[192:195], a[112:115], v[124:139]
    s_add_u32 m0, s5, 122880
    s_add_u32 s85, s74, 983040
    s_sub_u32 s84, s85, 1310720
    s_min_u32 s85, s85, s84
    v_mul_f32 v222, v118, v118
    v_mul_f32 v223, v119, v119
    v_fma_f32 v220, v220, v236, v234
    v_fma_f32 v221, v221, v236, v234
    v_fma_f32 v222, v222, v236, v234
    v_mfma_f32_32x32x16_bf16 v[124:139], a[216:219], a[116:119], v[124:139]
    buffer_load_dwordx4 v4, s[32:35], s85 offen lds
    v_fma_f32 v223, v223, v236, v234
    v_mul_f32 v220, v220, v116
    v_mul_f32 v221, v221, v117
    v_mul_f32 v222, v222, v118
    v_mul_f32 v223, v223, v119
    v_exp_f32 v220, v220
    v_mfma_f32_32x32x16_bf16 v[124:139], a[240:243], a[120:123], v[124:139]
    s_add_u32 m0, s5, 126976
    v_mul_f32 v116, v116, v120
    v_exp_f32 v221, v221
    v_mul_f32 v117, v117, v121
    v_exp_f32 v222, v222
    v_mul_f32 v118, v118, v122
    v_exp_f32 v223, v223
    v_mfma_f32_32x32x16_bf16 v[124:139], v[52:55], a[124:127], v[124:139]
    buffer_load_dwordx4 v27, s[32:35], s85 offen lds
    v_mul_f32 v119, v119, v123
    v_fma_f32 v220, v220, v232, v232
    v_rcp_f32 v220, v220
    v_fma_f32 v221, v221, v232, v232
    v_rcp_f32 v221, v221
    v_mfma_f32_32x32x16_bf16 v[124:139], v[204:207], v[212:215], v[124:139]
    v_fma_f32 v222, v222, v232, v232
    v_rcp_f32 v222, v222
    v_fma_f32 v223, v223, v232, v232
    v_rcp_f32 v223, v223
    v_mul_f32 v116, v116, v220
    v_mul_f32 v117, v117, v221
    v_mfma_f32_32x32x16_bf16 v[140:155], v[184:187], a[84:87], v[140:155]
    s_add_u32 m0, s5, 131072
    s_add_u32 s85, s74, 1048576
    s_sub_u32 s84, s85, 1310720
    s_min_u32 s85, s85, s84
    v_mul_f32 v118, v118, v222
    v_mul_f32 v119, v119, v223
    v_cvt_pk_bf16_f32 v246, v116, v117
    v_cvt_pk_bf16_f32 v247, v118, v119
    buffer_store_dwordx4 v[244:247], v2, s[12:15], s66 offen offset:1024 sc1
    v_mfma_f32_32x32x16_bf16 v[140:155], v[156:159], a[88:91], v[140:155]
    buffer_load_dwordx4 v4, s[32:35], s85 offen lds
    v_mul_f32 v216, v124, v124
    v_mul_f32 v217, v125, v125
    v_mul_f32 v218, v126, v126
    v_mul_f32 v219, v127, v127
    v_fma_f32 v216, v216, v236, v234
    v_fma_f32 v217, v217, v236, v234
    v_fma_f32 v218, v218, v236, v234
    v_mfma_f32_32x32x16_bf16 v[140:155], v[160:163], a[92:95], v[140:155]
    s_add_u32 m0, s5, 135168
    v_fma_f32 v219, v219, v236, v234
    v_mul_f32 v216, v216, v124
    v_mul_f32 v217, v217, v125
    v_mul_f32 v218, v218, v126
    v_mul_f32 v219, v219, v127
    v_exp_f32 v216, v216
    v_mfma_f32_32x32x16_bf16 v[140:155], v[164:167], a[96:99], v[140:155]
    buffer_load_dwordx4 v27, s[32:35], s85 offen lds
    v_mul_f32 v124, v124, v128
    v_exp_f32 v217, v217
    v_mul_f32 v125, v125, v129
    v_exp_f32 v218, v218
    v_mul_f32 v126, v126, v130
    v_mfma_f32_32x32x16_bf16 v[140:155], v[168:171], a[100:103], v[140:155]
    v_exp_f32 v219, v219
    v_mul_f32 v127, v127, v131
    v_fma_f32 v216, v216, v232, v232
    v_rcp_f32 v216, v216
    v_fma_f32 v217, v217, v232, v232
    v_rcp_f32 v217, v217
    v_mfma_f32_32x32x16_bf16 v[140:155], a[148:151], a[104:107], v[140:155]
    v_fma_f32 v218, v218, v232, v232
    v_rcp_f32 v218, v218
    v_fma_f32 v219, v219, v232, v232
    v_rcp_f32 v219, v219
    v_mul_f32 v124, v124, v216
    v_mfma_f32_32x32x16_bf16 v[140:155], a[172:175], a[108:111], v[140:155]
    v_mul_f32 v125, v125, v217
    v_mul_f32 v126, v126, v218
    v_mul_f32 v127, v127, v219
    v_cvt_pk_bf16_f32 v240, v124, v125
    v_cvt_pk_bf16_f32 v241, v126, v127
    v_mul_f32 v220, v132, v132
    v_mul_f32 v221, v133, v133
    v_mul_f32 v222, v134, v134
    v_mfma_f32_32x32x16_bf16 v[140:155], a[196:199], a[112:115], v[140:155]
    v_mul_f32 v223, v135, v135
    v_fma_f32 v220, v220, v236, v234
    v_fma_f32 v221, v221, v236, v234
    v_fma_f32 v222, v222, v236, v234
    v_fma_f32 v223, v223, v236, v234
    v_mul_f32 v220, v220, v132
    v_mul_f32 v221, v221, v133
    v_mul_f32 v222, v222, v134
    v_mfma_f32_32x32x16_bf16 v[140:155], a[220:223], a[116:119], v[140:155]
    v_mul_f32 v223, v223, v135
    v_exp_f32 v220, v220
    v_mul_f32 v132, v132, v136
    v_exp_f32 v221, v221
    v_mul_f32 v133, v133, v137
    v_exp_f32 v222, v222
    v_mfma_f32_32x32x16_bf16 v[140:155], a[244:247], a[120:123], v[140:155]
L_page_6:
    s_cbranch_execz L_pret
    v_mul_f32 v134, v134, v138
    v_exp_f32 v223, v223
    v_mul_f32 v135, v135, v139
    v_fma_f32 v220, v220, v232, v232
    v_rcp_f32 v220, v220
    v_mfma_f32_32x32x16_bf16 v[140:155], v[56:59], a[124:127], v[140:155]
    v_fma_f32 v221, v221, v232, v232
    v_rcp_f32 v221, v221
    v_fma_f32 v222, v222, v232, v232
    v_rcp_f32 v222, v222
    v_fma_f32 v223, v223, v232, v232
    v_rcp_f32 v223, v223
    v_mfma_f32_32x32x16_bf16 v[140:155], v[208:211], v[212:215], v[140:155]
    v_mul_f32 v132, v132, v220
    v_mul_f32 v133, v133, v221
    v_mul_f32 v134, v134, v222
    v_mul_f32 v135, v135, v223
    v_cvt_pk_bf16_f32 v242, v132, v133
    v_cvt_pk_bf16_f32 v243, v134, v135
    buffer_store_dwordx4 v[240:243], v2, s[12:15], s66 offen offset:2048 sc1
    s_nop 4
    v_pk_mul_f32 v[216:217], v[140:141], v[140:141]
    v_pk_mul_f32 v[218:219], v[142:143], v[142:143]
    v_pk_fma_f32 v[216:217], v[216:217], v[236:237], v[234:235] op_sel_hi:[1,0,0]
    v_pk_fma_f32 v[218:219], v[218:219], v[236:237], v[234:235] op_sel_hi:[1,0,0]
    v_pk_mul_f32 v[216:217], v[216:217], v[140:141]
    v_pk_mul_f32 v[218:219], v[218:219], v[142:143]
    v_exp_f32 v216, v216
    v_exp_f32 v217, v217
    v_exp_f32 v218, v218
    v_exp_f32 v219, v219
    v_pk_mul_f32 v[140:141], v[140:141], v[144:145]
    v_pk_mul_f32 v[142:143], v[142:143], v[146:147]
    v_pk_fma_f32 v[216:217], v[216:217], v[232:233], v[232:233] op_sel_hi:[1,0,0]
    v_pk_fma_f32 v[218:219], v[218:219], v[232:233], v[232:233] op_sel_hi:[1,0,0]
    v_rcp_f32 v216, v216
    v_rcp_f32 v217, v217
    v_rcp_f32 v218, v218
    v_rcp_f32 v219, v219
    v_pk_mul_f32 v[140:141], v[140:141], v[216:217]
    v_pk_mul_f32 v[142:143], v[142:143], v[218:219]
    v_cvt_pk_bf16_f32 v244, v140, v141
    v_cvt_pk_bf16_f32 v245, v142, v143
    v_pk_mul_f32 v[220:221], v[148:149], v[148:149]
    v_pk_mul_f32 v[222:223], v[150:151], v[150:151]
    v_pk_fma_f32 v[220:221], v[220:221], v[236:237], v[234:235] op_sel_hi:[1,0,0]
    v_pk_fma_f32 v[222:223], v[222:223], v[236:237], v[234:235] op_sel_hi:[1,0,0]
    v_pk_mul_f32 v[220:221], v[220:221], v[148:149]
    v_pk_mul_f32 v[222:223], v[222:223], v[150:151]
    v_exp_f32 v220, v220
    v_exp_f32 v221, v221
    v_exp_f32 v222, v222
    v_exp_f32 v223, v223
    v_pk_mul_f32 v[148:149], v[148:149], v[152:153]
    v_pk_mul_f32 v[150:151], v[150:151], v[154:155]
    v_pk_fma_f32 v[220:221], v[220:221], v[232:233], v[232:233] op_sel_hi:[1,0,0]
    v_pk_fma_f32 v[222:223], v[222:223], v[232:233], v[232:233] op_sel_hi:[1,0,0]
    v_rcp_f32 v220, v220
    v_rcp_f32 v221, v221
    v_rcp_f32 v222, v222
    v_rcp_f32 v223, v223
    v_pk_mul_f32 v[148:149], v[148:149], v[220:221]
    v_pk_mul_f32 v[150:151], v[150:151], v[222:223]
    v_cvt_pk_bf16_f32 v246, v148, v149
    v_cvt_pk_bf16_f32 v247, v150, v151
    buffer_store_dwordx4 v[244:247], v2, s[12:15], s66 offen offset:3072 sc1
    s_add_u32 m0, s5, 139264
    s_add_u32 s85, s85, 65536
    buffer_load_dwordx4 v4, s[32:35], s85 offen lds
    s_add_u32 m0, s5, 143360
    s_nop 0
    buffer_load_dwordx4 v27, s[32:35], s85 offen lds
    s_add_u32 m0, s5, 147456
    s_add_u32 s85, s74, 1179648
    s_sub_u32 s84, s85, 1310720
    s_min_u32 s85, s85, s84
    buffer_load_dwordx4 v4, s[32:35], s85 offen lds
    s_add_u32 m0, s5, 151552
    s_nop 0
    buffer_load_dwordx4 v27, s[32:35], s85 offen lds
    s_add_u32 m0, s5, 155648
    s_add_u32 s85, s85, 65536
    buffer_load_dwordx4 v4, s[32:35], s85 offen lds
L_join_51:
    s_lshl_b32 s63, s76, 11
    v_add_u32 v12, s63, v10
    v_add_u32 v13, s63, v11
    ds_read_b64_tr_b16 a[172:173], v12 offset:0
    ds_read_b64_tr_b16 a[174:175], v12 offset:1024
    ds_read_b64_tr_b16 a[176:177], v13 offset:0
    ds_read_b64_tr_b16 a[178:179], v13 offset:1024
    ds_read_b64_tr_b16 a[180:181], v12 offset:4096
    ds_read_b64_tr_b16 a[182:183], v12 offset:5120
    ds_read_b64_tr_b16 a[184:185], v13 offset:4096
    ds_read_b64_tr_b16 a[186:187], v13 offset:5120
    ds_read_b64_tr_b16 a[188:189], v12 offset:8192
    ds_read_b64_tr_b16 a[190:191], v12 offset:9216
    ds_read_b64_tr_b16 a[192:193], v13 offset:8192
    ds_read_b64_tr_b16 a[194:195], v13 offset:9216
    ds_read_b64_tr_b16 a[196:197], v12 offset:12288
    ds_read_b64_tr_b16 a[198:199], v12 offset:13312
    ds_read_b64_tr_b16 a[200:201], v13 offset:12288
    ds_read_b64_tr_b16 a[202:203], v13 offset:13312
    ds_read_b64_tr_b16 a[204:205], v12 offset:16384
    ds_read_b64_tr_b16 a[206:207], v12 offset:17408
    ds_read_b64_tr_b16 a[208:209], v13 offset:16384
    ds_read_b64_tr_b16 a[210:211], v13 offset:17408
    ds_read_b64_tr_b16 a[212:213], v12 offset:20480
    ds_read_b64_tr_b16 a[214:215], v12 offset:21504
    ds_read_b64_tr_b16 a[216:217], v13 offset:20480
    ds_read_b64_tr_b16 a[218:219], v13 offset:21504
    ds_read_b64_tr_b16 a[220:221], v12 offset:24576
    ds_read_b64_tr_b16 a[222:223], v12 offset:25600
    ds_read_b64_tr_b16 a[224:225], v13 offset:24576
    ds_read_b64_tr_b16 a[226:227], v13 offset:25600
    ds_read_b64_tr_b16 a[228:229], v12 offset:28672
    ds_read_b64_tr_b16 a[230:231], v12 offset:29696
    ds_read_b64_tr_b16 a[232:233], v13 offset:28672
    ds_read_b64_tr_b16 a[234:235], v13 offset:29696
    ds_read_b64_tr_b16 a[236:237], v12 offset:32768
    ds_read_b64_tr_b16 a[238:239], v12 offset:33792
    ds_read_b64_tr_b16 a[240:241], v13 offset:32768
    ds_read_b64_tr_b16 a[242:243], v13 offset:33792
    ds_read_b64_tr_b16 a[244:245], v12 offset:36864
    ds_read_b64_tr_b16 a[246:247], v12 offset:37888
    ds_read_b64_tr_b16 a[248:249], v13 offset:36864
    ds_read_b64_tr_b16 a[250:251], v13 offset:37888
    v_add_u32 v14, 65536, v12
    v_add_u32 v15, 65536, v13
    v_add_u32 v16, 131072, v12
    v_add_u32 v17, 131072, v13
    ds_read_b128 v[92:95], v19 offset:768
    ds_read_b128 v[96:99], v19 offset:800
    ds_read_b128 v[100:103], v19 offset:832
    ds_read_b128 v[104:107], v19 offset:864
    s_lshl2_add_u32 s64, s5, 16384
    v_add_u32 v125, s64, v2
    v_xor_b32 v126, 8192, v125
    s_mul_i32 s65, s77, 86
    s_add_u32 s65, s65, s76
    s_lshl_b32 s65, s65, 10
    s_add_u32 s65, s65, 425984
    v_add_u32 v127, s65, v2
    v_add_u32 v128, 4096, v127
    s_lshr_b32 s73, s74, 4
    s_mov_b32 s42, 81920
    s_add_u32 s3, s73, 8192
    s_cmp_eq_u32 s3, s42
    s_cselect_b32 s3, 0, s3
    s_add_u32 s6, s3, 8192
    s_cmp_eq_u32 s6, s42
    s_cselect_b32 s6, 0, s6
    s_add_u32 s7, s6, 8192
    s_cmp_eq_u32 s7, s42
    s_cselect_b32 s7, 0, s7
    s_add_u32 s26, s7, 8192
    s_cmp_eq_u32 s26, s42
    s_cselect_b32 s26, 0, s26
    s_add_u32 s27, s26, 8192
    s_cmp_eq_u32 s27, s42
    s_cselect_b32 s27, 0, s27
    s_add_u32 s30, s27, 8192
    s_cmp_eq_u32 s30, s42
    s_cselect_b32 s30, 0, s30
    s_add_u32 s31, s30, 8192
    s_cmp_eq_u32 s31, s42
    s_cselect_b32 s31, 0, s31
    s_add_u32 s40, s31, 8192
    s_cmp_eq_u32 s40, s42
    s_cselect_b32 s40, 0, s40
    s_add_u32 s41, s40, 8192
    s_cmp_eq_u32 s41, s42
    s_cselect_b32 s41, 0, s41
    s_waitcnt lgkmcnt(0)
    s_add_u32 s75, s72, 5
    v_mov_b32 v21, s75
    s_cmp_lg_u32 s29, 0
    s_waitcnt vmcnt(5)
    s_barrier
    s_cbranch_scc1 L_sig_56
    s_mov_b64 exec, 1
    buffer_store_dword v21, off, s[52:55], s71
    s_mov_b64 exec, -1
L_sig_56:
    s_cmp_eq_u32 s29, 2
    s_cbranch_scc1 L_far_57
L_back_58:
    s_add_u32 m0, s5, 0
    s_add_u32 s85, s74, 1245184
    s_sub_u32 s84, s85, 1310720
    s_min_u32 s85, s85, s84
    buffer_load_dwordx4 v27, s[32:35], s85 offen lds
    s_add_u32 m0, s5, 4096
    s_mov_b32 s85, 1310720
    buffer_load_dwordx4 v4, s[32:35], s85 offen lds
    s_add_u32 m0, s5, 8192
    s_nop 0
    buffer_load_dwordx4 v27, s[32:35], s85 offen lds
    s_add_u32 m0, s5, 12288
    s_mov_b32 s85, 1376256
    buffer_load_dwordx4 v4, s[32:35], s85 offen lds
    ds_read_b64_tr_b16 v[132:133], v13 offset:40960
    ds_read_b64_tr_b16 v[134:135], v13 offset:41984
    ds_read_b64_tr_b16 v[136:137], v12 offset:40960
    ds_read_b64_tr_b16 v[138:139], v12 offset:41984
    ds_read_b64_tr_b16 v[140:141], v13 offset:45056
    ds_read_b64_tr_b16 v[142:143], v13 offset:46080
    ds_read_b64_tr_b16 v[144:145], v12 offset:45056
    ds_read_b64_tr_b16 v[146:147], v12 offset:46080
    ds_read_b64_tr_b16 v[148:149], v13 offset:49152
    ds_read_b64_tr_b16 v[150:151], v13 offset:50176
    ds_read_b64_tr_b16 v[152:153], v12 offset:49152
    ds_read_b64_tr_b16 v[154:155], v12 offset:50176
    ds_read_b64_tr_b16 v[156:157], v13 offset:53248
    ds_read_b64_tr_b16 v[158:159], v13 offset:54272
    ds_read_b64_tr_b16 v[160:161], v12 offset:53248
    ds_read_b64_tr_b16 v[162:163], v12 offset:54272
    ds_read_b64_tr_b16 v[164:165], v13 offset:57344
    ds_read_b64_tr_b16 v[166:167], v13 offset:58368
    ds_read_b64_tr_b16 v[168:169], v12 offset:57344
    ds_read_b64_tr_b16 v[170:171], v12 offset:58368
    ds_read_b64_tr_b16 v[172:173], v13 offset:61440
    ds_read_b64_tr_b16 v[174:175], v13 offset:62464
    ds_read_b64_tr_b16 v[176:177], v12 offset:61440
    ds_read_b64_tr_b16 v[178:179], v12 offset:62464
    ds_read_b64_tr_b16 v[180:181], v15 offset:0
    ds_read_b64_tr_b16 v[182:183], v15 offset:1024
    ds_read_b64_tr_b16 v[184:185], v14 offset:0
    ds_read_b64_tr_b16 v[186:187], v14 offset:1024
    ds_read_b64_tr_b16 v[188:189], v15 offset:4096
    ds_read_b64_tr_b16 v[190:191], v15 offset:5120
    ds_read_b64_tr_b16 v[192:193], v14 offset:4096
    ds_read_b64_tr_b16 v[194:195], v14 offset:5120
    ds_read_b64_tr_b16 v[196:197], v15 offset:8192
    ds_read_b64_tr_b16 v[198:199], v15 offset:9216
    ds_read_b64_tr_b16 v[200:201], v14 offset:8192
    ds_read_b64_tr_b16 v[202:203], v14 offset:9216
    ds_read_b64_tr_b16 v[204:205], v15 offset:12288
    ds_read_b64_tr_b16 v[206:207], v15 offset:13312
    ds_read_b64_tr_b16 v[208:209], v14 offset:12288
    ds_read_b64_tr_b16 v[210:211], v14 offset:13312
    ds_read_b64_tr_b16 v[212:213], v15 offset:16384
    ds_read_b64_tr_b16 v[214:215], v15 offset:17408
    ds_read_b64_tr_b16 v[216:217], v14 offset:16384
    ds_read_b64_tr_b16 v[218:219], v14 offset:17408
    ds_read_b64_tr_b16 v[220:221], v15 offset:20480
    ds_read_b64_tr_b16 v[222:223], v15 offset:21504
    ds_read_b64_tr_b16 v[224:225], v14 offset:20480
    ds_read_b64_tr_b16 v[226:227], v14 offset:21504
    s_mov_b64 exec, 32767
    s_mov_b32 s67, 0
    s_add_u32 s75, s72, 5
L_poll_59:
    buffer_load_dword v21, v18, s[52:55], 0 offen sc1
    s_add_u32 s67, s67, 1
    s_waitcnt vmcnt(0)
    v_subrev_u32 v21, s75, v21
    v_cmp_lt_u32 vcc, 5, v21
    s_cbranch_vccz L_polld_60
    s_cmp_lt_u32 s67, 20000
    s_cbranch_scc1 L_poll_59
L_polld_60:
    s_mov_b64 exec, -1
    buffer_load_dwordx4 a[0:3], v127, s[16:19], s73 offen offset:0 sc1
    buffer_load_dwordx4 a[4:7], v127, s[16:19], s73 offen offset:2048 sc1
    buffer_load_dwordx4 a[8:11], v128, s[16:19], s73 offen offset:0 sc1
    buffer_load_dwordx4 a[12:15], v128, s[16:19], s73 offen offset:2048 sc1
    buffer_load_dwordx4 a[16:19], v127, s[16:19], s3 offen offset:0 sc1
    buffer_load_dwordx4 a[20:23], v127, s[16:19], s3 offen offset:2048 sc1
    buffer_load_dwordx4 a[24:27], v128, s[16:19], s3 offen offset:0 sc1
    buffer_load_dwordx4 a[28:31], v128, s[16:19], s3 offen offset:2048 sc1
    buffer_load_dwordx4 a[32:35], v127, s[16:19], s6 offen offset:0 sc1
    s_barrier
    s_waitcnt vmcnt(8)
    v_mfma_f32_32x32x16_bf16 v[76:91], a[176:179], a[0:3], 0
    buffer_load_dwordx4 a[36:39], v127, s[16:19], s6 offen offset:2048 sc1
    v_mfma_f32_32x32x16_bf16 v[60:75], a[172:175], a[0:3], 0
    s_waitcnt vmcnt(8)
    v_mfma_f32_32x32x16_bf16 v[76:91], a[184:187], a[4:7], v[76:91]
    buffer_load_dwordx4 a[40:43], v128, s[16:19], s6 offen offset:0 sc1
    v_mfma_f32_32x32x16_bf16 v[60:75], a[180:183], a[4:7], v[60:75]
    s_waitcnt vmcnt(8)
    v_mfma_f32_32x32x16_bf16 v[76:91], a[192:195], a[8:11], v[76:91]
    buffer_load_dwordx4 a[44:47], v128, s[16:19], s6 offen offset:2048 sc1
    v_mfma_f32_32x32x16_bf16 v[60:75], a[188:191], a[8:11], v[60:75]
    s_waitcnt vmcnt(8)
    v_mfma_f32_32x32x16_bf16 v[76:91], a[200:203], a[12:15], v[76:91]
    buffer_load_dwordx4 a[48:51], v127, s[16:19], s7 offen offset:0 sc1
    v_mfma_f32_32x32x16_bf16 v[60:75], a[196:199], a[12:15], v[60:75]
    s_waitcnt vmcnt(8)
    v_mfma_f32_32x32x16_bf16 v[76:91], a[208:211], a[16:19], v[76:91]
    buffer_load_dwordx4 a[52:55], v127, s[16:19], s7 offen offset:2048 sc1
    v_mfma_f32_32x32x16_bf16 v[60:75], a[204:207], a[16:19], v[60:75]
    s_waitcnt vmcnt(8)
    v_mfma_f32_32x32x16_bf16 v[76:91], a[216:219], a[20:23], v[76:91]
    buffer_load_dwordx4 a[56:59], v128, s[16:19], s7 offen offset:0 sc1
    v_mfma_f32_32x32x16_bf16 v[60:75], a[212:215], a[20:23], v[60:75]
    s_waitcnt vmcnt(8)
    v_mfma_f32_32x32x16_bf16 v[76:91], a[224:227], a[24:27], v[76:91]
    buffer_load_dwordx4 a[60:63], v128, s[16:19], s7 offen offset:2048 sc1
    v_mfma_f32_32x32x16_bf16 v[60:75], a[220:223], a[24:27], v[60:75]
    s_waitcnt vmcnt(8)
    v_mfma_f32_32x32x16_bf16 v[76:91], a[232:235], a[28:31], v[76:91]
    buffer_load_dwordx4 a[64:67], v127, s[16:19], s26 offen offset:0 sc1
    v_mfma_f32_32x32x16_bf16 v[60:75], a[228:231], a[28:31], v[60:75]
    s_waitcnt vmcnt(8)
    v_mfma_f32_32x32x16_bf16 v[76:91], a[240:243], a[32:35], v[76:91]
    buffer_load_dwordx4 a[68:71], v127, s[16:19], s26 offen offset:2048 sc1
    v_mfma_f32_32x32x16_bf16 v[60:75], a[236:239], a[32:35], v[60:75]
    s_waitcnt vmcnt(8)
    v_mfma_f32_32x32x16_bf16 v[76:91], a[248:251], a[36:39], v[76:91]
    buffer_load_dwordx4 a[72:75], v128, s[16:19], s26 offen offset:0 sc1
    v_mfma_f32_32x32x16_bf16 v[60:75], a[244:247], a[36:39], v[60:75]
    s_waitcnt vmcnt(8) lgkmcnt(8)
    v_mfma_f32_32x32x16_bf16 v[76:91], v[132:135], a[40:43], v[76:91]
    ds_read_b64_tr_b16 v[228:229], v15 offset:24576
    ds_read_b64_tr_b16 v[230:231], v15 offset:25600
    buffer_load_dwordx4 a[76:79], v128, s[16:19], s26 offen offset:2048 sc1
    v_mfma_f32_32x32x16_bf16 v[60:75], v[136:139], a[40:43], v[60:75]
    ds_read_b64_tr_b16 v[232:233], v14 offset:24576
    ds_read_b64_tr_b16 v[234:235], v14 offset:25600
    s_waitcnt vmcnt(8)
    v_mfma_f32_32x32x16_bf16 v[76:91], v[140:143], a[44:47], v[76:91]
    ds_read_b64_tr_b16 v[236:237], v15 offset:28672
    ds_read_b64_tr_b16 v[238:239], v15 offset:29696
    buffer_load_dwordx4 a[80:83], v127, s[16:19], s27 offen offset:0 sc1
    v_mfma_f32_32x32x16_bf16 v[60:75], v[144:147], a[44:47], v[60:75]
    ds_read_b64_tr_b16 v[240:241], v14 offset:28672
    ds_read_b64_tr_b16 v[242:243], v14 offset:29696
    s_waitcnt vmcnt(8)
    v_mfma_f32_32x32x16_bf16 v[76:91], v[148:151], a[48:51], v[76:91]
    ds_read_b64_tr_b16 v[132:133], v15 offset:32768
    ds_read_b64_tr_b16 v[134:135], v15 offset:33792
    buffer_load_dwordx4 a[84:87], v127, s[16:19], s27 offen offset:2048 sc1
    v_mfma_f32_32x32x16_bf16 v[60:75], v[152:155], a[48:51], v[60:75]
    ds_read_b64_tr_b16 v[136:137], v14 offset:32768
    ds_read_b64_tr_b16 v[138:139], v14 offset:33792
    s_waitcnt vmcnt(8)
    v_mfma_f32_32x32x16_bf16 v[76:91], v[156:159], a[52:55], v[76:91]
    ds_read_b64_tr_b16 v[140:141], v15 offset:36864
    ds_read_b64_tr_b16 v[142:143], v15 offset:37888
    buffer_load_dwordx4 a[88:91], v128, s[16:19], s27 offen offset:0 sc1
    v_mfma_f32_32x32x16_bf16 v[60:75], v[160:163], a[52:55], v[60:75]
    ds_read_b64_tr_b16 v[144:145], v14 offset:36864
    ds_read_b64_tr_b16 v[146:147], v14 offset:37888
    s_waitcnt vmcnt(8)
    v_mfma_f32_32x32x16_bf16 v[76:91], v[164:167], a[56:59], v[76:91]
    ds_read_b64_tr_b16 v[148:149], v15 offset:40960
    ds_read_b64_tr_b16 v[150:151], v15 offset:41984
    buffer_load_dwordx4 a[92:95], v128, s[16:19], s27 offen offset:2048 sc1
    v_mfma_f32_32x32x16_bf16 v[60:75], v[168:171], a[56:59], v[60:75]
    ds_read_b64_tr_b16 v[152:153], v14 offset:40960
    ds_read_b64_tr_b16 v[154:155], v14 offset:41984
    s_waitcnt vmcnt(8)
    v_mfma_f32_32x32x16_bf16 v[76:91], v[172:175], a[60:63], v[76:91]
    ds_read_b64_tr_b16 v[156:157], v15 offset:45056
    ds_read_b64_tr_b16 v[158:159], v15 offset:46080
    buffer_load_dwordx4 a[96:99], v127, s[16:19], s30 offen offset:0 sc1
    v_mfma_f32_32x32x16_bf16 v[60:75], v[176:179], a[60:63], v[60:75]
    ds_read_b64_tr_b16 v[160:161], v14 offset:45056
    ds_read_b64_tr_b16 v[162:163], v14 offset:46080
    s_waitcnt vmcnt(8)
    v_mfma_f32_32x32x16_bf16 v[76:91], v[180:183], a[64:67], v[76:91]
    ds_read_b64_tr_b16 v[164:165], v15 offset:49152
    ds_read_b64_tr_b16 v[166:167], v15 offset:50176
    buffer_load_dwordx4 a[100:103], v127, s[16:19], s30 offen offset:2048 sc1
    v_mfma_f32_32x32x16_bf16 v[60:75], v[184:187], a[64:67], v[60:75]
    ds_read_b64_tr_b16 v[168:169], v14 offset:49152
    ds_read_b64_tr_b16 v[170:171], v14 offset:50176
    s_waitcnt vmcnt(8)
    v_mfma_f32_32x32x16_bf16 v[76:91], v[188:191], a[68:71], v[76:91]
    ds_read_b64_tr_b16 v[172:173], v15 offset:53248
    ds_read_b64_tr_b16 v[174:175], v15 offset:54272
    buffer_load_dwordx4 a[104:107], v128, s[16:19], s30 offen offset:0 sc1
    v_mfma_f32_32x32x16_bf16 v[60:75], v[192:195], a[68:71], v[60:75]
    ds_read_b64_tr_b16 v[176:177], v14 offset:53248
    ds_read_b64_tr_b16 v[178:179], v14 offset:54272
    s_waitcnt vmcnt(8)
    v_mfma_f32_32x32x16_bf16 v[76:91], v[196:199], a[72:75], v[76:91]
    ds_read_b64_tr_b16 v[180:181], v15 offset:57344
    ds_read_b64_tr_b16 v[182:183], v15 offset:58368
    buffer_load_dwordx4 a[108:111], v128, s[16:19], s30 offen offset:2048 sc1
    v_mfma_f32_32x32x16_bf16 v[60:75], v[200:203], a[72:75], v[60:75]
    ds_read_b64_tr_b16 v[184:185], v14 offset:57344
    ds_read_b64_tr_b16 v[186:187], v14 offset:58368
    s_waitcnt vmcnt(8)
    v_mfma_f32_32x32x16_bf16 v[76:91], v[204:207], a[76:79], v[76:91]
    ds_read_b64_tr_b16 v[188:189], v15 offset:61440
    ds_read_b64_tr_b16 v[190:191], v15 offset:62464
    buffer_load_dwordx4 a[112:115], v127, s[16:19], s31 offen offset:0 sc1
    v_mfma_f32_32x32x16_bf16 v[60:75], v[208:211], a[76:79], v[60:75]
    ds_read_b64_tr_b16 v[192:193], v14 offset:61440
    ds_read_b64_tr_b16 v[194:195], v14 offset:62464
    s_waitcnt vmcnt(8) lgkmcnt(8)
    v_mfma_f32_32x32x16_bf16 v[76:91], v[212:215], a[80:83], v[76:91]
    ds_read_b64_tr_b16 v[196:197], v17 offset:0
    ds_read_b64_tr_b16 v[198:199], v17 offset:1024
    buffer_load_dwordx4 a[116:119], v127, s[16:19], s31 offen offset:2048 sc1
    v_mfma_f32_32x32x16_bf16 v[60:75], v[216:219], a[80:83], v[60:75]
    ds_read_b64_tr_b16 v[200:201], v16 offset:0
    ds_read_b64_tr_b16 v[202:203], v16 offset:1024
    s_waitcnt vmcnt(8)
    v_mfma_f32_32x32x16_bf16 v[76:91], v[220:223], a[84:87], v[76:91]
    ds_read_b64_tr_b16 v[204:205], v17 offset:4096
    ds_read_b64_tr_b16 v[206:207], v17 offset:5120
    buffer_load_dwordx4 a[120:123], v128, s[16:19], s31 offen offset:0 sc1
    v_mfma_f32_32x32x16_bf16 v[60:75], v[224:227], a[84:87], v[60:75]
    ds_read_b64_tr_b16 v[208:209], v16 offset:4096
    ds_read_b64_tr_b16 v[210:211], v16 offset:5120
    s_waitcnt vmcnt(8)
    v_mfma_f32_32x32x16_bf16 v[76:91], v[228:231], a[88:91], v[76:91]
    ds_read_b64_tr_b16 v[212:213], v17 offset:8192
    ds_read_b64_tr_b16 v[214:215], v17 offset:9216
    buffer_load_dwordx4 a[124:127], v128, s[16:19], s31 offen offset:2048 sc1
    v_mfma_f32_32x32x16_bf16 v[60:75], v[232:235], a[88:91], v[60:75]
    ds_read_b64_tr_b16 v[216:217], v16 offset:8192
    ds_read_b64_tr_b16 v[218:219], v16 offset:9216
    s_waitcnt vmcnt(8)
    v_mfma_f32_32x32x16_bf16 v[76:91], v[236:239], a[92:95], v[76:91]
    ds_read_b64_tr_b16 v[220:221], v17 offset:12288
    ds_read_b64_tr_b16 v[222:223], v17 offset:13312
    buffer_load_dwordx4 a[128:131], v127, s[16:19], s40 offen offset:0 sc1
    v_mfma_f32_32x32x16_bf16 v[60:75], v[240:243], a[92:95], v[60:75]
    ds_read_b64_tr_b16 v[224:225], v16 offset:12288
    ds_read_b64_tr_b16 v[226:227], v16 offset:13312
    s_waitcnt vmcnt(8)
    v_mfma_f32_32x32x16_bf16 v[76:91], v[132:135], a[96:99], v[76:91]
    ds_read_b64_tr_b16 v[228:229], v17 offset:16384
    ds_read_b64_tr_b16 v[230:231], v17 offset:17408
    buffer_load_dwordx4 a[132:135], v127, s[16:19], s40 offen offset:2048 sc1
    v_mfma_f32_32x32x16_bf16 v[60:75], v[136:139], a[96:99], v[60:75]
    ds_read_b64_tr_b16 v[232:233], v16 offset:16384
    ds_read_b64_tr_b16 v[234:235], v16 offset:17408
    s_waitcnt vmcnt(8)
    v_mfma_f32_32x32x16_bf16 v[76:91], v[140:143], a[100:103], v[76:91]
    ds_read_b64_tr_b16 v[236:237], v17 offset:20480
    ds_read_b64_tr_b16 v[238:239], v17 offset:21504
    buffer_load_dwordx4 a[136:139], v128, s[16:19], s40 offen offset:0 sc1
    v_mfma_f32_32x32x16_bf16 v[60:75], v[144:147], a[100:103], v[60:75]
    ds_read_b64_tr_b16 v[240:241], v16 offset:20480
    ds_read_b64_tr_b16 v[242:243], v16 offset:21504
    s_waitcnt vmcnt(8)
    v_mfma_f32_32x32x16_bf16 v[76:91], v[148:151], a[104:107], v[76:91]
    ds_read_b64_tr_b16 v[132:133], v17 offset:24576
    ds_read_b64_tr_b16 v[134:135], v17 offset:25600
    buffer_load_dwordx4 a[140:143], v128, s[16:19], s40 offen offset:2048 sc1
    v_mfma_f32_32x32x16_bf16 v[60:75], v[152:155], a[104:107], v[60:75]
    ds_read_b64_tr_b16 v[136:137], v16 offset:24576
    ds_read_b64_tr_b16 v[138:139], v16 offset:25600
    s_waitcnt vmcnt(8)
    v_mfma_f32_32x32x16_bf16 v[76:91], v[156:159], a[108:111], v[76:91]
    ds_read_b64_tr_b16 v[140:141], v13 offset:0
    ds_read_b64_tr_b16 v[142:143], v13 offset:1024
    buffer_load_dwordx4 a[144:147], v127, s[16:19], s41 offen offset:0 sc1
    v_mfma_f32_32x32x16_bf16 v[60:75], v[160:163], a[108:111], v[60:75]
    ds_read_b64_tr_b16 v[144:145], v12 offset:0
    ds_read_b64_tr_b16 v[146:147], v12 offset:1024
    s_waitcnt vmcnt(8)
    v_mfma_f32_32x32x16_bf16 v[76:91], v[164:167], a[112:115], v[76:91]
    ds_read_b64_tr_b16 v[148:149], v13 offset:4096
    ds_read_b64_tr_b16 v[150:151], v13 offset:5120
    buffer_load_dwordx4 a[148:151], v127, s[16:19], s41 offen offset:2048 sc1
    v_mfma_f32_32x32x16_bf16 v[60:75], v[168:171], a[112:115], v[60:75]
    ds_read_b64_tr_b16 v[152:153], v12 offset:4096
    ds_read_b64_tr_b16 v[154:155], v12 offset:5120
    s_waitcnt vmcnt(8)
    v_mfma_f32_32x32x16_bf16 v[76:91], v[172:175], a[116:119], v[76:91]
    ds_read_b64_tr_b16 v[156:157], v13 offset:8192
    ds_read_b64_tr_b16 v[158:159], v13 offset:9216
    buffer_load_dwordx4 a[152:155], v128, s[16:19], s41 offen offset:0 sc1
    v_mfma_f32_32x32x16_bf16 v[60:75], v[176:179], a[116:119], v[60:75]
    ds_read_b64_tr_b16 v[160:161], v12 offset:8192
    ds_read_b64_tr_b16 v[162:163], v12 offset:9216
    s_waitcnt vmcnt(8) lgkmcnt(8)
    v_mfma_f32_32x32x16_bf16 v[76:91], v[180:183], a[120:123], v[76:91]
    ds_read_b64_tr_b16 v[164:165], v13 offset:12288
    ds_read_b64_tr_b16 v[166:167], v13 offset:13312
    buffer_load_dwordx4 a[156:159], v128, s[16:19], s41 offen offset:2048 sc1
    v_mfma_f32_32x32x16_bf16 v[60:75], v[184:187], a[120:123], v[60:75]
    ds_read_b64_tr_b16 v[168:169], v12 offset:12288
    ds_read_b64_tr_b16 v[170:171], v12 offset:13312
    s_waitcnt vmcnt(8)
    v_mfma_f32_32x32x16_bf16 v[76:91], v[188:191], a[124:127], v[76:91]
    buffer_load_dwordx4 a[160:163], v127, s[16:19], s42 offen offset:0 sc1
    v_mfma_f32_32x32x16_bf16 v[60:75], v[192:195], a[124:127], v[60:75]
    s_waitcnt vmcnt(8)
    v_mfma_f32_32x32x16_bf16 v[76:91], v[196:199], a[128:131], v[76:91]
    buffer_load_dwordx4 a[164:167], v127, s[16:19], s42 offen offset:2048 sc1
    v_mfma_f32_32x32x16_bf16 v[60:75], v[200:203], a[128:131], v[60:75]
    s_waitcnt vmcnt(8)
    v_mfma_f32_32x32x16_bf16 v[76:91], v[204:207], a[132:135], v[76:91]
    buffer_load_dwordx4 a[168:171], v128, s[16:19], s42 offen offset:0 sc1
    v_mfma_f32_32x32x16_bf16 v[60:75], v[208:211], a[132:135], v[60:75]
    s_waitcnt vmcnt(8)
    v_mfma_f32_32x32x16_bf16 v[76:91], v[212:215], a[136:139], v[76:91]
    v_mfma_f32_32x32x16_bf16 v[60:75], v[216:219], a[136:139], v[60:75]
    s_waitcnt vmcnt(7)
    v_mfma_f32_32x32x16_bf16 v[76:91], v[220:223], a[140:143], v[76:91]
    v_mfma_f32_32x32x16_bf16 v[60:75], v[224:227], a[140:143], v[60:75]
    s_waitcnt vmcnt(6)
    v_mfma_f32_32x32x16_bf16 v[76:91], v[228:231], a[144:147], v[76:91]
    v_mfma_f32_32x32x16_bf16 v[60:75], v[232:235], a[144:147], v[60:75]
    s_waitcnt vmcnt(5)
    v_mfma_f32_32x32x16_bf16 v[76:91], v[236:239], a[148:151], v[76:91]
    v_mfma_f32_32x32x16_bf16 v[60:75], v[240:243], a[148:151], v[60:75]
    s_waitcnt vmcnt(4)
    v_mfma_f32_32x32x16_bf16 v[76:91], v[132:135], a[152:155], v[76:91]
    v_mfma_f32_32x32x16_bf16 v[60:75], v[136:139], a[152:155], v[60:75]
    s_waitcnt vmcnt(3)
    v_mfma_f32_32x32x16_bf16 v[76:91], v[140:143], a[156:159], v[76:91]
    v_mfma_f32_32x32x16_bf16 v[60:75], v[144:147], a[156:159], v[60:75]
    s_waitcnt vmcnt(2) lgkmcnt(8)
    v_mfma_f32_32x32x16_bf16 v[76:91], v[148:151], a[160:163], v[76:91]
    v_mfma_f32_32x32x16_bf16 v[60:75], v[152:155], a[160:163], v[60:75]
    s_waitcnt vmcnt(1) lgkmcnt(6)
    v_mfma_f32_32x32x16_bf16 v[76:91], v[156:159], a[164:167], v[76:91]
    s_waitcnt lgkmcnt(4)
    v_mfma_f32_32x32x16_bf16 v[60:75], v[160:163], a[164:167], v[60:75]
    s_waitcnt vmcnt(0) lgkmcnt(2)
    v_mfma_f32_32x32x16_bf16 v[76:91], v[164:167], a[168:171], v[76:91]
    s_waitcnt lgkmcnt(0)
    v_mfma_f32_32x32x16_bf16 v[60:75], v[168:171], a[168:171], v[60:75]
    s_nop 9
    ds_write_b128 v125, v[76:79] offset:0
    ds_write_b128 v125, v[80:83] offset:1024
    ds_write_b128 v125, v[84:87] offset:2048
    ds_write_b128 v125, v[88:91] offset:3072
    s_waitcnt lgkmcnt(0)
    s_barrier
    ds_read_b128 v[108:111], v126 offset:0
    ds_read_b128 v[112:115], v126 offset:1024
    ds_read_b128 v[116:119], v126 offset:2048
    ds_read_b128 v[120:123], v126 offset:3072
    s_waitcnt lgkmcnt(3)
    v_pk_add_f32 v[60:61], v[60:61], v[108:109]
    v_pk_add_f32 v[62:63], v[62:63], v[110:111]
    s_waitcnt lgkmcnt(2)
    v_pk_add_f32 v[64:65], v[64:65], v[112:113]
    v_pk_add_f32 v[66:67], v[66:67], v[114:115]
    v_pk_fma_f32 v[28:29], v[60:61], v[92:93], v[28:29]
    v_pk_fma_f32 v[30:31], v[62:63], v[94:95], v[30:31]
    v_pk_fma_f32 v[32:33], v[64:65], v[96:97], v[32:33]
    v_pk_fma_f32 v[34:35], v[66:67], v[98:99], v[34:35]
    v_cvt_pk_bf16_f32 v76, v28, v29
    v_cvt_pk_bf16_f32 v77, v30, v31
    v_cvt_pk_bf16_f32 v78, v32, v33
    v_cvt_pk_bf16_f32 v79, v34, v35
    s_nop 0
    v_permlane32_swap_b32 v76, v78
    v_permlane32_swap_b32 v77, v79
    buffer_store_dwordx4 v[76:79], v20, s[44:47], s36 offen offset:0
    s_waitcnt lgkmcnt(1)
    v_pk_add_f32 v[68:69], v[68:69], v[116:117]
    v_pk_add_f32 v[70:71], v[70:71], v[118:119]
    s_waitcnt lgkmcnt(0)
    v_pk_add_f32 v[72:73], v[72:73], v[120:121]
    v_pk_add_f32 v[74:75], v[74:75], v[122:123]
    v_pk_fma_f32 v[36:37], v[68:69], v[100:101], v[36:37]
    v_pk_fma_f32 v[38:39], v[70:71], v[102:103], v[38:39]
    v_pk_fma_f32 v[40:41], v[72:73], v[104:105], v[40:41]
    v_pk_fma_f32 v[42:43], v[74:75], v[106:107], v[42:43]
    v_cvt_pk_bf16_f32 v80, v36, v37
    v_cvt_pk_bf16_f32 v81, v38, v39
    v_cvt_pk_bf16_f32 v82, v40, v41
    v_cvt_pk_bf16_f32 v83, v42, v43
    s_nop 0
    v_permlane32_swap_b32 v80, v82
    v_permlane32_swap_b32 v81, v83
    buffer_store_dwordx4 v[80:83], v20, s[44:47], s36 offen offset:32
L_end:
    s_endpgm
L_m15_50:
    s_add_u32 m0, s4, 135168
    s_mul_i32 s84, s27, 43
    s_add_u32 s84, s84, 88064
    buffer_load_dwordx4 v5, s[56:59], s84 offen offset:0 lds
    buffer_load_dwordx4 v6, s[56:59], s84 offen offset:1024 lds
    buffer_load_dwordx4 v7, s[56:59], s84 offen offset:2048 lds
    s_add_u32 m0, s4, 147456
    s_mul_i32 s84, s30, 43
    buffer_load_dwordx4 v5, s[56:59], s84 offen offset:0 lds
    buffer_load_dwordx4 v6, s[56:59], s84 offen offset:1024 lds
    buffer_load_dwordx4 v7, s[56:59], s84 offen offset:2048 lds
    v_and_b32 v124, 1, v1
    v_lshlrev_b32 v124, 10, v124
    v_lshrrev_b32 v125, 5, v1
    v_lshl_add_u32 v124, v125, 4, v124
    v_add_u32 v124, 159744, v124
    s_lshl_b32 s63, s62, 6
    ds_read_b128 a[104:107], v124 offset:832
    ds_read_b128 a[108:111], v124 offset:864
L_page_7:
    s_cbranch_execz L_pret
    ds_read_b128 a[112:115], v124 offset:896
    ds_read_b128 a[116:119], v124 offset:928
    ds_read_b128 a[120:123], v124 offset:960
    ds_read_b128 a[124:127], v124 offset:992
    ds_read_b128 a[0:3], v124 offset:0
    ds_read_b128 a[4:7], v124 offset:32
    ds_read_b128 a[8:11], v124 offset:64
    ds_read_b128 a[12:15], v124 offset:96
    ds_read_b128 a[16:19], v124 offset:128
    ds_read_b128 a[20:23], v124 offset:160
    ds_read_b128 a[24:27], v124 offset:192
    ds_read_b128 a[28:31], v124 offset:224
    ds_read_b128 a[32:35], v124 offset:256
    ds_read_b128 a[36:39], v124 offset:288
    ds_read_b128 a[40:43], v124 offset:320
    ds_read_b128 a[44:47], v124 offset:352
    ds_read_b128 a[48:51], v124 offset:384
    ds_read_b128 a[52:55], v124 offset:416
    ds_read_b128 a[56:59], v124 offset:448
    ds_read_b128 a[60:63], v124 offset:480
    ds_read_b128 a[64:67], v124 offset:512
    ds_read_b128 a[68:71], v124 offset:544
    ds_read_b128 a[72:75], v124 offset:576
    ds_read_b128 a[76:79], v124 offset:608
    ds_read_b128 a[80:83], v124 offset:640
    ds_read_b128 a[84:87], v124 offset:672
    ds_read_b128 a[88:91], v124 offset:704
    ds_read_b128 a[92:95], v124 offset:736
    ds_read_b128 a[96:99], v124 offset:768
    ds_read_b128 a[100:103], v124 offset:800
    v_add_u32 v12, s63, v12
    v_add_u32 v13, s63, v13
    v_add_u32 v14, s63, v14
    v_add_u32 v15, s63, v15
    v_add_u32 v16, s63, v16
    v_add_u32 v17, s63, v17
    ds_read_b64_tr_b16 v[92:93], v12 offset:0
    ds_read_b64_tr_b16 v[94:95], v12 offset:1536
    ds_read_b64_tr_b16 v[96:97], v13 offset:32
    ds_read_b64_tr_b16 v[98:99], v13 offset:1568
    ds_read_b64_tr_b16 v[100:101], v12 offset:6144
    ds_read_b64_tr_b16 v[102:103], v12 offset:7680
    ds_read_b64_tr_b16 v[104:105], v13 offset:6176
    ds_read_b64_tr_b16 v[106:107], v13 offset:7712
    ds_read_b64_tr_b16 v[108:109], v12 offset:12288
    ds_read_b64_tr_b16 v[110:111], v12 offset:13824
    s_waitcnt lgkmcnt(10)
    s_cmp_lg_u32 s62, 0
    s_cbranch_scc1 L_m15n_62
    v_mfma_f32_32x32x16_bf16 v[60:75], a[104:107], a[128:131], 0
    v_mfma_f32_32x32x16_bf16 v[76:91], a[104:107], a[132:135], 0
    v_mfma_f32_32x32x16_bf16 v[60:75], a[108:111], a[152:155], v[60:75]
    v_mfma_f32_32x32x16_bf16 v[76:91], a[108:111], a[156:159], v[76:91]
    v_mfma_f32_32x32x16_bf16 v[60:75], a[112:115], a[176:179], v[60:75]
    v_mfma_f32_32x32x16_bf16 v[76:91], a[112:115], a[180:183], v[76:91]
    v_mfma_f32_32x32x16_bf16 v[60:75], a[116:119], a[200:203], v[60:75]
    v_mfma_f32_32x32x16_bf16 v[76:91], a[116:119], a[204:207], v[76:91]
    v_mfma_f32_32x32x16_bf16 v[60:75], a[120:123], a[224:227], v[60:75]
    v_mfma_f32_32x32x16_bf16 v[76:91], a[120:123], a[228:231], v[76:91]
    v_mfma_f32_32x32x16_bf16 v[60:75], a[124:127], a[248:251], v[60:75]
    v_mfma_f32_32x32x16_bf16 v[76:91], a[124:127], a[252:255], v[76:91]
    s_branch L_m15d_61
L_m15n_62:
    s_cmp_lg_u32 s62, 1
    s_cbranch_scc1 L_m15n_63
    v_mfma_f32_32x32x16_bf16 v[60:75], a[104:107], a[136:139], 0
    v_mfma_f32_32x32x16_bf16 v[76:91], a[104:107], a[140:143], 0
    v_mfma_f32_32x32x16_bf16 v[60:75], a[108:111], a[160:163], v[60:75]
    v_mfma_f32_32x32x16_bf16 v[76:91], a[108:111], a[164:167], v[76:91]
    v_mfma_f32_32x32x16_bf16 v[60:75], a[112:115], a[184:187], v[60:75]
    v_mfma_f32_32x32x16_bf16 v[76:91], a[112:115], a[188:191], v[76:91]
    v_mfma_f32_32x32x16_bf16 v[60:75], a[116:119], a[208:211], v[60:75]
    v_mfma_f32_32x32x16_bf16 v[76:91], a[116:119], a[212:215], v[76:91]
    v_mfma_f32_32x32x16_bf16 v[60:75], a[120:123], a[232:235], v[60:75]
    v_mfma_f32_32x32x16_bf16 v[76:91], a[120:123], a[236:239], v[76:91]
    v_mfma_f32_32x32x16_bf16 v[60:75], a[124:127], v[44:47], v[60:75]
    v_mfma_f32_32x32x16_bf16 v[76:91], a[124:127], v[48:51], v[76:91]
    s_branch L_m15d_61
L_m15n_63:
    v_mfma_f32_32x32x16_bf16 v[60:75], a[104:107], a[144:147], 0
    v_mfma_f32_32x32x16_bf16 v[76:91], a[104:107], a[148:151], 0
    v_mfma_f32_32x32x16_bf16 v[60:75], a[108:111], a[168:171], v[60:75]
    v_mfma_f32_32x32x16_bf16 v[76:91], a[108:111], a[172:175], v[76:91]
    v_mfma_f32_32x32x16_bf16 v[60:75], a[112:115], a[192:195], v[60:75]
    v_mfma_f32_32x32x16_bf16 v[76:91], a[112:115], a[196:199], v[76:91]
    v_mfma_f32_32x32x16_bf16 v[60:75], a[116:119], a[216:219], v[60:75]
    v_mfma_f32_32x32x16_bf16 v[76:91], a[116:119], a[220:223], v[76:91]
    v_mfma_f32_32x32x16_bf16 v[60:75], a[120:123], a[240:243], v[60:75]
    v_mfma_f32_32x32x16_bf16 v[76:91], a[120:123], a[244:247], v[76:91]
    v_mfma_f32_32x32x16_bf16 v[60:75], a[124:127], v[52:55], v[60:75]
    v_mfma_f32_32x32x16_bf16 v[76:91], a[124:127], v[56:59], v[76:91]
L_m15d_61:
    s_waitcnt lgkmcnt(8)
    v_mfma_f32_32x32x16_bf16 v[60:75], a[0:3], v[92:95], v[60:75]
    ds_read_b64_tr_b16 v[112:113], v13 offset:12320
    ds_read_b64_tr_b16 v[114:115], v13 offset:13856
    s_waitcnt lgkmcnt(8)
    v_mfma_f32_32x32x16_bf16 v[76:91], a[0:3], v[96:99], v[76:91]
    ds_read_b64_tr_b16 v[116:117], v12 offset:18432
    ds_read_b64_tr_b16 v[118:119], v12 offset:19968
    s_waitcnt lgkmcnt(8)
    v_mfma_f32_32x32x16_bf16 v[60:75], a[4:7], v[100:103], v[60:75]
    ds_read_b64_tr_b16 v[120:121], v13 offset:18464
    ds_read_b64_tr_b16 v[122:123], v13 offset:20000
    s_waitcnt lgkmcnt(8)
    v_mfma_f32_32x32x16_bf16 v[76:91], a[4:7], v[104:107], v[76:91]
    ds_read_b64_tr_b16 v[92:93], v12 offset:24576
    ds_read_b64_tr_b16 v[94:95], v12 offset:26112
    s_waitcnt lgkmcnt(8)
    v_mfma_f32_32x32x16_bf16 v[60:75], a[8:11], v[108:111], v[60:75]
    ds_read_b64_tr_b16 v[96:97], v13 offset:24608
    ds_read_b64_tr_b16 v[98:99], v13 offset:26144
    s_waitcnt lgkmcnt(8)
    v_mfma_f32_32x32x16_bf16 v[76:91], a[8:11], v[112:115], v[76:91]
    ds_read_b64_tr_b16 v[100:101], v12 offset:30720
    ds_read_b64_tr_b16 v[102:103], v12 offset:32256
    s_waitcnt lgkmcnt(8)
    v_mfma_f32_32x32x16_bf16 v[60:75], a[12:15], v[116:119], v[60:75]
    ds_read_b64_tr_b16 v[104:105], v13 offset:30752
    ds_read_b64_tr_b16 v[106:107], v13 offset:32288
    s_waitcnt lgkmcnt(8)
    v_mfma_f32_32x32x16_bf16 v[76:91], a[12:15], v[120:123], v[76:91]
    ds_read_b64_tr_b16 v[108:109], v12 offset:36864
    ds_read_b64_tr_b16 v[110:111], v12 offset:38400
    s_waitcnt lgkmcnt(8)
    v_mfma_f32_32x32x16_bf16 v[60:75], a[16:19], v[92:95], v[60:75]
    ds_read_b64_tr_b16 v[112:113], v13 offset:36896
    ds_read_b64_tr_b16 v[114:115], v13 offset:38432
    s_waitcnt lgkmcnt(8)
    v_mfma_f32_32x32x16_bf16 v[76:91], a[16:19], v[96:99], v[76:91]
    ds_read_b64_tr_b16 v[116:117], v12 offset:43008
    ds_read_b64_tr_b16 v[118:119], v12 offset:44544
    s_waitcnt lgkmcnt(8)
    v_mfma_f32_32x32x16_bf16 v[60:75], a[20:23], v[100:103], v[60:75]
    ds_read_b64_tr_b16 v[120:121], v13 offset:43040
    ds_read_b64_tr_b16 v[122:123], v13 offset:44576
    s_waitcnt lgkmcnt(8)
    v_mfma_f32_32x32x16_bf16 v[76:91], a[20:23], v[104:107], v[76:91]
    ds_read_b64_tr_b16 v[92:93], v12 offset:49152
    ds_read_b64_tr_b16 v[94:95], v12 offset:50688
    s_waitcnt lgkmcnt(8)
    v_mfma_f32_32x32x16_bf16 v[60:75], a[24:27], v[108:111], v[60:75]
    ds_read_b64_tr_b16 v[96:97], v13 offset:49184
    ds_read_b64_tr_b16 v[98:99], v13 offset:50720
    s_waitcnt lgkmcnt(8)
    v_mfma_f32_32x32x16_bf16 v[76:91], a[24:27], v[112:115], v[76:91]
    ds_read_b64_tr_b16 v[100:101], v12 offset:55296
    ds_read_b64_tr_b16 v[102:103], v12 offset:56832
    s_waitcnt lgkmcnt(8)
    v_mfma_f32_32x32x16_bf16 v[60:75], a[28:31], v[116:119], v[60:75]
    ds_read_b64_tr_b16 v[104:105], v13 offset:55328
    ds_read_b64_tr_b16 v[106:107], v13 offset:56864
    s_waitcnt lgkmcnt(8)
    v_mfma_f32_32x32x16_bf16 v[76:91], a[28:31], v[120:123], v[76:91]
    ds_read_b64_tr_b16 v[108:109], v14 offset:0
    ds_read_b64_tr_b16 v[110:111], v14 offset:1536
    s_waitcnt lgkmcnt(8)
    v_mfma_f32_32x32x16_bf16 v[60:75], a[32:35], v[92:95], v[60:75]
    ds_read_b64_tr_b16 v[112:113], v15 offset:32
    ds_read_b64_tr_b16 v[114:115], v15 offset:1568
    s_waitcnt lgkmcnt(8)
    v_mfma_f32_32x32x16_bf16 v[76:91], a[32:35], v[96:99], v[76:91]
    ds_read_b64_tr_b16 v[116:117], v14 offset:6144
    ds_read_b64_tr_b16 v[118:119], v14 offset:7680
    s_waitcnt lgkmcnt(8)
    v_mfma_f32_32x32x16_bf16 v[60:75], a[36:39], v[100:103], v[60:75]
    ds_read_b64_tr_b16 v[120:121], v15 offset:6176
    ds_read_b64_tr_b16 v[122:123], v15 offset:7712
    s_waitcnt lgkmcnt(8)
    v_mfma_f32_32x32x16_bf16 v[76:91], a[36:39], v[104:107], v[76:91]
    ds_read_b64_tr_b16 v[92:93], v14 offset:12288
    ds_read_b64_tr_b16 v[94:95], v14 offset:13824
    s_waitcnt lgkmcnt(8)
    v_mfma_f32_32x32x16_bf16 v[60:75], a[40:43], v[108:111], v[60:75]
    ds_read_b64_tr_b16 v[96:97], v15 offset:12320
    ds_read_b64_tr_b16 v[98:99], v15 offset:13856
    s_waitcnt lgkmcnt(8)
    v_mfma_f32_32x32x16_bf16 v[76:91], a[40:43], v[112:115], v[76:91]
    ds_read_b64_tr_b16 v[100:101], v14 offset:18432
    ds_read_b64_tr_b16 v[102:103], v14 offset:19968
    s_waitcnt lgkmcnt(8)
    v_mfma_f32_32x32x16_bf16 v[60:75], a[44:47], v[116:119], v[60:75]
    ds_read_b64_tr_b16 v[104:105], v15 offset:18464
    ds_read_b64_tr_b16 v[106:107], v15 offset:20000
    s_waitcnt lgkmcnt(8)
    v_mfma_f32_32x32x16_bf16 v[76:91], a[44:47], v[120:123], v[76:91]
    ds_read_b64_tr_b16 v[108:109], v14 offset:24576
    ds_read_b64_tr_b16 v[110:111], v14 offset:26112
    s_waitcnt lgkmcnt(8)
    v_mfma_f32_32x32x16_bf16 v[60:75], a[48:51], v[92:95], v[60:75]
    ds_read_b64_tr_b16 v[112:113], v15 offset:24608
    ds_read_b64_tr_b16 v[114:115], v15 offset:26144
    s_waitcnt lgkmcnt(8)
    v_mfma_f32_32x32x16_bf16 v[76:91], a[48:51], v[96:99], v[76:91]
    ds_read_b64_tr_b16 v[116:117], v14 offset:30720
    ds_read_b64_tr_b16 v[118:119], v14 offset:32256
    s_waitcnt vmcnt(0)
    s_barrier
    s_waitcnt lgkmcnt(8)
    v_mfma_f32_32x32x16_bf16 v[60:75], a[52:55], v[100:103], v[60:75]
    ds_read_b64_tr_b16 v[120:121], v15 offset:30752
    ds_read_b64_tr_b16 v[122:123], v15 offset:32288
    s_waitcnt lgkmcnt(8)
    v_mfma_f32_32x32x16_bf16 v[76:91], a[52:55], v[104:107], v[76:91]
    ds_read_b64_tr_b16 v[92:93], v14 offset:36864
    ds_read_b64_tr_b16 v[94:95], v14 offset:38400
    s_waitcnt lgkmcnt(8)
    v_mfma_f32_32x32x16_bf16 v[60:75], a[56:59], v[108:111], v[60:75]
    ds_read_b64_tr_b16 v[96:97], v15 offset:36896
    ds_read_b64_tr_b16 v[98:99], v15 offset:38432
    s_waitcnt lgkmcnt(8)
    v_mfma_f32_32x32x16_bf16 v[76:91], a[56:59], v[112:115], v[76:91]
    ds_read_b64_tr_b16 v[100:101], v14 offset:43008
    ds_read_b64_tr_b16 v[102:103], v14 offset:44544
    s_waitcnt lgkmcnt(8)
    v_mfma_f32_32x32x16_bf16 v[60:75], a[60:63], v[116:119], v[60:75]
    ds_read_b64_tr_b16 v[104:105], v15 offset:43040
    ds_read_b64_tr_b16 v[106:107], v15 offset:44576
    s_waitcnt lgkmcnt(8)
    v_mfma_f32_32x32x16_bf16 v[76:91], a[60:63], v[120:123], v[76:91]
    ds_read_b64_tr_b16 v[108:109], v14 offset:49152
    ds_read_b64_tr_b16 v[110:111], v14 offset:50688
    s_waitcnt lgkmcnt(8)
    v_mfma_f32_32x32x16_bf16 v[60:75], a[64:67], v[92:95], v[60:75]
    ds_read_b64_tr_b16 v[112:113], v15 offset:49184
    ds_read_b64_tr_b16 v[114:115], v15 offset:50720
    s_waitcnt lgkmcnt(8)
    v_mfma_f32_32x32x16_bf16 v[76:91], a[64:67], v[96:99], v[76:91]
    ds_read_b64_tr_b16 v[116:117], v14 offset:55296
    ds_read_b64_tr_b16 v[118:119], v14 offset:56832
    s_waitcnt lgkmcnt(8)
    v_mfma_f32_32x32x16_bf16 v[60:75], a[68:71], v[100:103], v[60:75]
    ds_read_b64_tr_b16 v[120:121], v15 offset:55328
    ds_read_b64_tr_b16 v[122:123], v15 offset:56864
    s_waitcnt lgkmcnt(8)
    v_mfma_f32_32x32x16_bf16 v[76:91], a[68:71], v[104:107], v[76:91]
    ds_read_b64_tr_b16 v[92:93], v16 offset:0
    ds_read_b64_tr_b16 v[94:95], v16 offset:1536
    s_waitcnt lgkmcnt(8)
    v_mfma_f32_32x32x16_bf16 v[60:75], a[72:75], v[108:111], v[60:75]
    ds_read_b64_tr_b16 v[96:97], v17 offset:32
    ds_read_b64_tr_b16 v[98:99], v17 offset:1568
    s_waitcnt lgkmcnt(8)
    v_mfma_f32_32x32x16_bf16 v[76:91], a[72:75], v[112:115], v[76:91]
    ds_read_b64_tr_b16 v[100:101], v16 offset:6144
    ds_read_b64_tr_b16 v[102:103], v16 offset:7680
    s_waitcnt lgkmcnt(8)
    v_mfma_f32_32x32x16_bf16 v[60:75], a[76:79], v[116:119], v[60:75]
    ds_read_b64_tr_b16 v[104:105], v17 offset:6176
    ds_read_b64_tr_b16 v[106:107], v17 offset:7712
    s_waitcnt lgkmcnt(8)
    v_mfma_f32_32x32x16_bf16 v[76:91], a[76:79], v[120:123], v[76:91]
    ds_read_b64_tr_b16 v[108:109], v16 offset:12288
    ds_read_b64_tr_b16 v[110:111], v16 offset:13824
    s_waitcnt lgkmcnt(8)
    v_mfma_f32_32x32x16_bf16 v[60:75], a[80:83], v[92:95], v[60:75]
    ds_read_b64_tr_b16 v[112:113], v17 offset:12320
    ds_read_b64_tr_b16 v[114:115], v17 offset:13856
    s_waitcnt lgkmcnt(8)
    v_mfma_f32_32x32x16_bf16 v[76:91], a[80:83], v[96:99], v[76:91]
    ds_read_b64_tr_b16 v[116:117], v16 offset:18432
    ds_read_b64_tr_b16 v[118:119], v16 offset:19968
    s_waitcnt lgkmcnt(8)
    v_mfma_f32_32x32x16_bf16 v[60:75], a[84:87], v[100:103], v[60:75]
    ds_read_b64_tr_b16 v[120:121], v17 offset:18464
    ds_read_b64_tr_b16 v[122:123], v17 offset:20000
    s_waitcnt lgkmcnt(8)
    v_mfma_f32_32x32x16_bf16 v[76:91], a[84:87], v[104:107], v[76:91]
    ds_read_b64_tr_b16 v[92:93], v16 offset:24576
    ds_read_b64_tr_b16 v[94:95], v16 offset:26112
    s_waitcnt lgkmcnt(8)
    v_mfma_f32_32x32x16_bf16 v[60:75], a[88:91], v[108:111], v[60:75]
    ds_read_b64_tr_b16 v[96:97], v17 offset:24608
    ds_read_b64_tr_b16 v[98:99], v17 offset:26144
    s_waitcnt lgkmcnt(8)
    v_mfma_f32_32x32x16_bf16 v[76:91], a[88:91], v[112:115], v[76:91]
    ds_read_b64_tr_b16 v[100:101], v16 offset:30720
    ds_read_b64_tr_b16 v[102:103], v16 offset:32256
    s_waitcnt lgkmcnt(8)
    v_mfma_f32_32x32x16_bf16 v[60:75], a[92:95], v[116:119], v[60:75]
    ds_read_b64_tr_b16 v[104:105], v17 offset:30752
    ds_read_b64_tr_b16 v[106:107], v17 offset:32288
    s_waitcnt lgkmcnt(8)
    v_mfma_f32_32x32x16_bf16 v[76:91], a[92:95], v[120:123], v[76:91]
    s_waitcnt lgkmcnt(6)
    v_mfma_f32_32x32x16_bf16 v[60:75], a[96:99], v[92:95], v[60:75]
    s_waitcnt lgkmcnt(4)
    v_mfma_f32_32x32x16_bf16 v[76:91], a[96:99], v[96:99], v[76:91]
    s_waitcnt lgkmcnt(2)
    v_mfma_f32_32x32x16_bf16 v[60:75], a[100:103], v[100:103], v[60:75]
    s_waitcnt lgkmcnt(0)
    v_mfma_f32_32x32x16_bf16 v[76:91], a[100:103], v[104:107], v[76:91]
    s_barrier
    s_lshl_b32 s79, s60, 12
    s_add_u32 s79, s79, s5
    s_add_u32 s79, s79, 1179648
    v_cmp_gt_u32 vcc, 32, v1
    v_mov_b32 v131, s82
    s_nop 5
    v_cndmask_b32 v124, v76, v60, vcc
    v_cndmask_b32 v125, v77, v61, vcc
    v_cvt_pk_bf16_f32 v126, 0, v124
    v_cvt_pk_bf16_f32 v127, 0, v125
    v_sub_f32 v126, v124, v126
    v_sub_f32 v127, v125, v127
    v_cvt_pk_bf16_f32 v128, v125, v127
    v_cvt_pk_bf16_f32 v129, v125, v124
    v_cvt_pk_bf16_f32 v130, v126, v124
    buffer_store_dwordx4 v[128:131], v2, s[52:55], s79 offen sc1
    s_and_b32 s63, s60, 1
    s_lshl2_add_u32 s63, s63, s62
    s_mul_i32 s63, s63, 12288
    s_add_u32 s63, s63, 1310720
    s_add_u32 s64, s63, 4096
    v_lshlrev_b32 v124, 7, v1
    buffer_load_dword v255, v124, s[32:35], s63 offen
    buffer_load_dword v255, v124, s[32:35], s64 offen
    s_add_u32 m0, s5, 0
    s_add_u32 s85, s74, 0
    s_sub_u32 s84, s85, 1310720
    s_min_u32 s85, s85, s84
    buffer_load_dwordx4 v4, s[32:35], s85 offen lds
    s_add_u32 m0, s5, 4096
    s_nop 0
    buffer_load_dwordx4 v27, s[32:35], s85 offen lds
    s_add_u32 m0, s5, 8192
    s_add_u32 s85, s85, 65536
    buffer_load_dwordx4 v4, s[32:35], s85 offen lds
    s_add_u32 m0, s5, 12288
    s_nop 0
    buffer_load_dwordx4 v27, s[32:35], s85 offen lds
    s_add_u32 m0, s5, 16384
    s_add_u32 s85, s74, 131072
    s_sub_u32 s84, s85, 1310720
    s_min_u32 s85, s85, s84
    buffer_load_dwordx4 v4, s[32:35], s85 offen lds
    s_add_u32 m0, s5, 20480
    s_nop 0
    buffer_load_dwordx4 v27, s[32:35], s85 offen lds
    s_add_u32 m0, s5, 24576
    s_add_u32 s85, s85, 65536
    buffer_load_dwordx4 v4, s[32:35], s85 offen lds
    s_add_u32 m0, s5, 28672
    s_nop 0
    buffer_load_dwordx4 v27, s[32:35], s85 offen lds
    s_add_u32 m0, s5, 32768
    s_add_u32 s85, s74, 262144
    s_sub_u32 s84, s85, 1310720
    s_min_u32 s85, s85, s84
    buffer_load_dwordx4 v4, s[32:35], s85 offen lds
    s_add_u32 m0, s5, 36864
    s_nop 0
    buffer_load_dwordx4 v27, s[32:35], s85 offen lds
    s_add_u32 m0, s5, 40960
    s_add_u32 s85, s85, 65536
    buffer_load_dwordx4 v4, s[32:35], s85 offen lds
    s_add_u32 m0, s5, 45056
    s_nop 0
    buffer_load_dwordx4 v27, s[32:35], s85 offen lds
    s_add_u32 m0, s5, 49152
    s_add_u32 s85, s74, 393216
    s_sub_u32 s84, s85, 1310720
    s_min_u32 s85, s85, s84
    buffer_load_dwordx4 v4, s[32:35], s85 offen lds
    s_add_u32 m0, s5, 53248
    s_nop 0
    buffer_load_dwordx4 v27, s[32:35], s85 offen lds
    s_add_u32 m0, s5, 57344
    s_add_u32 s85, s85, 65536
    buffer_load_dwordx4 v4, s[32:35], s85 offen lds
    s_add_u32 m0, s5, 61440
    s_nop 0
    buffer_load_dwordx4 v27, s[32:35], s85 offen lds
    s_add_u32 m0, s5, 65536
    s_add_u32 s85, s74, 524288
    s_sub_u32 s84, s85, 1310720
    s_min_u32 s85, s85, s84
    buffer_load_dwordx4 v4, s[32:35], s85 offen lds
    s_add_u32 m0, s5, 69632
    s_nop 0
    buffer_load_dwordx4 v27, s[32:35], s85 offen lds
    s_add_u32 m0, s5, 73728
    s_add_u32 s85, s85, 65536
    buffer_load_dwordx4 v4, s[32:35], s85 offen lds
    s_add_u32 m0, s5, 77824
    s_nop 0
    buffer_load_dwordx4 v27, s[32:35], s85 offen lds
    s_add_u32 m0, s5, 81920
    s_add_u32 s85, s74, 655360
    s_sub_u32 s84, s85, 1310720
    s_min_u32 s85, s85, s84
    buffer_load_dwordx4 v4, s[32:35], s85 offen lds
    s_add_u32 m0, s5, 86016
    s_nop 0
    buffer_load_dwordx4 v27, s[32:35], s85 offen lds
    s_add_u32 m0, s5, 90112
    s_add_u32 s85, s85, 65536
    buffer_load_dwordx4 v4, s[32:35], s85 offen lds
    s_add_u32 m0, s5, 94208
    s_nop 0
    buffer_load_dwordx4 v27, s[32:35], s85 offen lds
    s_add_u32 m0, s5, 98304
    s_add_u32 s85, s74, 786432
    s_sub_u32 s84, s85, 1310720
    s_min_u32 s85, s85, s84
    buffer_load_dwordx4 v4, s[32:35], s85 offen lds
    s_add_u32 m0, s5, 102400
    s_nop 0
    buffer_load_dwordx4 v27, s[32:35], s85 offen lds
    s_add_u32 m0, s5, 106496
    s_add_u32 s85, s85, 65536
    buffer_load_dwordx4 v4, s[32:35], s85 offen lds
    s_add_u32 m0, s5, 110592
    s_nop 0
    buffer_load_dwordx4 v27, s[32:35], s85 offen lds
    s_add_u32 m0, s5, 114688
    s_add_u32 s85, s74, 917504
    s_sub_u32 s84, s85, 1310720
    s_min_u32 s85, s85, s84
    buffer_load_dwordx4 v4, s[32:35], s85 offen lds
    s_add_u32 m0, s5, 118784
    s_nop 0
    buffer_load_dwordx4 v27, s[32:35], s85 offen lds
    s_add_u32 m0, s5, 122880
    s_add_u32 s85, s85, 65536
    buffer_load_dwordx4 v4, s[32:35], s85 offen lds
    s_add_u32 m0, s5, 126976
    s_nop 0
    buffer_load_dwordx4 v27, s[32:35], s85 offen lds
    s_add_u32 m0, s5, 131072
    s_add_u32 s85, s74, 1048576
    s_sub_u32 s84, s85, 1310720
    s_min_u32 s85, s85, s84
    buffer_load_dwordx4 v4, s[32:35], s85 offen lds
    s_add_u32 m0, s5, 135168
    s_nop 0
    buffer_load_dwordx4 v27, s[32:35], s85 offen lds
    s_add_u32 m0, s5, 139264
    s_add_u32 s85, s85, 65536
    buffer_load_dwordx4 v4, s[32:35], s85 offen lds
    s_add_u32 m0, s5, 143360
    s_nop 0
    buffer_load_dwordx4 v27, s[32:35], s85 offen lds
    s_add_u32 m0, s5, 147456
    s_add_u32 s85, s74, 1179648
    s_sub_u32 s84, s85, 1310720
    s_min_u32 s85, s85, s84
    buffer_load_dwordx4 v4, s[32:35], s85 offen lds
    s_add_u32 m0, s5, 151552
    s_nop 0
    buffer_load_dwordx4 v27, s[32:35], s85 offen lds
    s_add_u32 m0, s5, 155648
    s_add_u32 s85, s85, 65536
    buffer_load_dwordx4 v4, s[32:35], s85 offen lds
    s_waitcnt vmcnt(0) lgkmcnt(0)
    s_barrier
    s_branch L_join_51
L_far_12:
    s_nop 3
    buffer_store_dwordx4 v[100:103], v20, s[44:47], 0 offen sc1
    s_nop 1
    s_branch L_back_13
L_far_14:
    s_nop 3
    buffer_store_dwordx4 v[104:107], v20, s[44:47], s63 offen sc1
    s_nop 1
    s_branch L_back_15
L_far_18:
    s_mov_b64 exec, 1
    buffer_store_dword v21, off, s[52:55], s71 sc1
    s_mov_b64 exec, -1
    s_branch L_back_19
L_kvrt_24:
    s_sub_u32 s65, s65, 27648
    buffer_load_dwordx4 v[164:167], v70, s[52:55], s65 offen offset:0 sc1
    buffer_load_dwordx4 v[168:171], v70, s[52:55], s65 offen offset:256 sc1
    s_add_u32 s65, s65, 9216
    buffer_load_dwordx4 v[172:175], v70, s[52:55], s65 offen offset:0 sc1
    buffer_load_dwordx4 v[176:179], v70, s[52:55], s65 offen offset:256 sc1
    s_add_u32 s65, s65, 9216
    buffer_load_dwordx4 v[180:183], v70, s[52:55], s65 offen offset:0 sc1
    buffer_load_dwordx4 v[184:187], v70, s[52:55], s65 offen offset:256 sc1
    s_add_u32 s65, s65, 9216
    buffer_load_dwordx4 v[188:191], v70, s[52:55], s65 offen offset:0 sc1
    buffer_load_dwordx4 v[192:195], v70, s[52:55], s65 offen offset:256 sc1
    buffer_load_dwordx4 v[136:139], v71, s[52:55], 0 offen offset:2048 sc1
    s_add_u32 s67, s67, 1
    s_waitcnt vmcnt(0)
    s_cmp_lt_u32 s67, 20000
    s_cbranch_scc1 L_kvchk_23
    s_branch L_kvok_25
L_far_26:
    s_nop 3
    buffer_store_dwordx4 v[228:231], v2, s[16:19], s82 offen offset:0 sc1
    s_nop 1
    s_branch L_back_27
L_far_28:
    s_nop 3
    buffer_store_dwordx4 v[232:235], v2, s[16:19], s82 offen offset:1024 sc1
    s_nop 1
    s_branch L_back_29
L_far_33:
    s_mov_b64 exec, 1
    buffer_store_dword v21, off, s[52:55], s71 sc1
    s_mov_b64 exec, -1
    s_branch L_back_34
L_far_41:
    s_nop 3
    buffer_store_dwordx4 v[140:143], v2, s[44:47], s80 offen offset:0 sc1
    s_nop 1
    s_branch L_back_42
L_far_43:
    s_nop 3
    buffer_store_dwordx4 v[144:147], v2, s[44:47], s80 offen offset:1024 sc1
    s_nop 1
    s_branch L_back_44
L_far_45:
    s_nop 3
    buffer_store_dword v210, v207, s[16:19], s79 offen sc1
    s_nop 1
    s_branch L_back_46
L_far_48:
    s_mov_b64 exec, 1
    buffer_store_dword v21, off, s[52:55], s71 sc1
    s_mov_b64 exec, -1
    s_branch L_back_49
L_far_57:
    s_mov_b64 exec, 1
    buffer_store_dword v21, off, s[52:55], s71 sc1
    s_mov_b64 exec, -1
    s_branch L_back_58
L_last:
    s_endpgm
.section .rodata,"a"
.p2align 6
.amdhsa_kernel adaLN_cond__linear_kernel_hedgehog__geglu_ffn__prompt_kernel
  .amdhsa_next_free_vgpr 512
  .amdhsa_next_free_sgpr 102
  .amdhsa_accum_offset 256
  .amdhsa_group_segment_fixed_size 0
  .amdhsa_kernarg_size 104
  .amdhsa_user_sgpr_count 2
  .amdhsa_user_sgpr_kernarg_segment_ptr 1
  .amdhsa_system_sgpr_workgroup_id_x 1
  .amdhsa_float_denorm_mode_32 3
.end_amdhsa_kernel
```
